```python
import torch

def _softmax(x, axis=-1):
    return torch.softmax(x, dim=axis)
def _gelu(x):
    return torch.nn.functional.gelu(x, approximate="tanh")
def _silu(x):
    return torch.nn.functional.silu(x)
def _sigmoid(x):
    return torch.sigmoid(x)
def _layernorm(x, axis=-1, eps=1e-5):
    m = x.mean(dim=axis, keepdim=True)
    v = x.var(dim=axis, keepdim=True, unbiased=False)
    return (x - m) / torch.sqrt(v + eps)
def _scatter_add(tgt, idx, src, axis=0):
    return tgt.clone().index_add_(axis, idx, src)
def _segment_sum(src, seg, n):
    out = torch.zeros((n,) + src.shape[1:], dtype=src.dtype)
    return out.index_add_(0, seg, src)
def _pad(x, pw):
    flat = tuple(v for pair in reversed(pw) for v in pair)
    return torch.nn.functional.pad(x, flat)

kernel_name = 'parallel_sum__gqa_block_cached__glu_gated_geglu__decode'

def setup_inputs():

    _w = (lambda a: (lambda t: t.to(torch.bfloat16) if t.is_floating_point() else t)(torch.as_tensor(a)))
    def _A_setup():
        B, Sq, D = 4, 1, 448
        Hq, Hkv, Sk, Dh = 16, 8, 8192, 256
        assert Hq % Hkv == 0, (Hq, Hkv)
        return {
            "x": _w((lambda *s: torch.randn(*s, dtype=torch.bfloat16) * 0.05)(B, Sq, D)),
            "k_cache": _w((lambda *s: torch.randn(*s, dtype=torch.bfloat16) * 1.6)(B, Hkv, Sk, Dh)),
            "v_cache": _w((lambda *s: torch.randn(*s, dtype=torch.bfloat16) * 0.8)(B, Hkv, Sk, Dh)),
            "wq": _w((lambda *s: torch.randn(*s, dtype=torch.bfloat16) * 1.6)(D, Hq * Dh) * (D ** -0.5)),
            "wo": _w((lambda *s: torch.randn(*s, dtype=torch.bfloat16) * 0.8)(Hq * Dh, D) * ((Hq * Dh) ** -0.5)),
        }
    _A_in = _A_setup()

    def _B_setup():
        B, S, Dm, Df = 4, 1, 448, 1792
        return {
            "x": _w((lambda *s: torch.randn(*s, dtype=torch.bfloat16) * 0.05)(B, S, Dm)),
            "w_gate": _w((lambda *s: torch.randn(*s, dtype=torch.bfloat16) * 0.4)(Dm, Df) * (Dm ** -0.5)),
            "w_up": _w((lambda *s: torch.randn(*s, dtype=torch.bfloat16) * 0.4)(Dm, Df) * (Dm ** -0.5)),
            "w_down": _w((lambda *s: torch.randn(*s, dtype=torch.bfloat16) * 0.4)(Df, Dm) * (Df ** -0.5)),
        }
    _B_in = _B_setup()

    return {
        "A_x": _A_in["x"],
        "A_k_cache": _A_in["k_cache"],
        "A_v_cache": _A_in["v_cache"],
        "A_wq": _A_in["wq"],
        "A_wo": _A_in["wo"],
        "B_x": _B_in["x"],
        "B_w_gate": _B_in["w_gate"],
        "B_w_up": _B_in["w_up"],
        "B_w_down": _B_in["w_down"],
    }

def reference(A_x, A_k_cache, A_v_cache, A_wq, A_wo, B_x, B_w_gate, B_w_up, B_w_down):
    def _A_ref(x, k_cache, v_cache, wq, wo):
        B, Sq, D = x.shape
        Hq, Dh = 16, 256
        Hkv = k_cache.shape[1]
        rep = Hq // Hkv
        q = (lambda x, *d: x.permute(*d))((x @ wq).reshape(B, Sq, Hq, Dh), 0, 2, 1, 3)
        k = (lambda x, n, axis: torch.repeat_interleave(x, n, dim=axis))(k_cache, rep, axis=1)
        v = (lambda x, n, axis: torch.repeat_interleave(x, n, dim=axis))(v_cache, rep, axis=1)
        scores = torch.einsum("bhqd,bhkd->bhqk", q, k) * (Dh ** -0.5)
        p = _softmax(scores, axis=-1)
        o = torch.einsum("bhqk,bhkd->bhqd", p, v)
        return (lambda x, *d: x.permute(*d))(o, 0, 2, 1, 3).reshape(B, Sq, Hq * Dh) @ wo

    def _B_ref(x, w_gate, w_up, w_down):
        g = torch.einsum("bsd,df->bsf", x, w_gate)
        u = torch.einsum("bsd,df->bsf", x, w_up)
        h = _gelu(g) * u
        return torch.einsum("bsf,fd->bsd", h, w_down)

    x = A_x
    xn = _layernorm(x, axis=-1)
    return x + _A_ref(xn, A_k_cache, A_v_cache, A_wq, A_wo) + _B_ref(xn, B_w_gate, B_w_up, B_w_down)
```

```asm
; @launch grid=(256,1,1) block=(512,1,1) lds=163008
.amdgcn_target "amdgcn-amd-amdhsa--gfx950"
.text
.globl parallel_sum__gqa_block_cached__glu_gated_geglu__decode_kernel
.p2align 8
.type parallel_sum__gqa_block_cached__glu_gated_geglu__decode_kernel,@function
parallel_sum__gqa_block_cached__glu_gated_geglu__decode_kernel:
    s_cmp_ge_u32 s2, 256
    s_cbranch_scc1 L_end
    s_load_dwordx16 s[4:19], s[0:1], 0
    s_load_dwordx8 s[20:27], s[0:1], 64
    v_lshrrev_b32 v2, 6, v0
    v_and_b32 v1, 63, v0
    v_mov_b32 v205, 0
    v_mov_b32 v206, 0
    v_mov_b32 v207, 0
    v_mov_b32 v28, 0
    s_mov_b32 s86, 0
    v_readfirstlane_b32 s3, v2
    s_lshr_b32 s44, s2, 3
    s_and_b32 s60, s2, 7
    s_lshr_b32 s46, s2, 6
    s_and_b32 s47, s44, 7
    s_add_u32 s45, s60, s47
    s_and_b32 s45, s45, 7
    s_lshl_b32 s61, s44, 3
    s_add_u32 s61, s61, s45
    s_cmp_lt_u32 s3, 4
    s_cbranch_scc1 L_help
L_stream:
    s_sub_u32 s48, s3, 4
    s_lshl_b32 s49, s48, 15
    v_lshrrev_b32 v2, 5, v1
    v_and_b32 v3, 31, v1
    v_lshlrev_b32 v4, 1, v2
    v_lshlrev_b32 v5, 9, v2
    v_xor_b32 v6, 0, v4
    v_xor_b32 v6, v6, v3
    v_lshlrev_b32 v6, 4, v6
    v_add_u32 v10, v5, v6
    v_xor_b32 v6, 4, v4
    v_xor_b32 v6, v6, v3
    v_lshlrev_b32 v6, 4, v6
    v_add_u32 v11, v5, v6
    v_xor_b32 v6, 8, v4
    v_xor_b32 v6, v6, v3
    v_lshlrev_b32 v6, 4, v6
    v_add_u32 v12, v5, v6
    v_xor_b32 v6, 12, v4
    v_xor_b32 v6, v6, v3
    v_lshlrev_b32 v6, 4, v6
    v_add_u32 v13, v5, v6
    v_lshlrev_b32 v4, 2, v2
    v_xor_b32 v6, 0, v4
    v_xor_b32 v6, v6, v3
    v_lshlrev_b32 v6, 4, v6
    v_add_u32 v28, v5, v6
    v_xor_b32 v6, 8, v4
    v_xor_b32 v6, v6, v3
    v_lshlrev_b32 v6, 4, v6
    v_add_u32 v29, v5, v6
    v_xor_b32 v6, 0, v4
    v_xor_b32 v6, v6, v3
    v_lshlrev_b32 v6, 4, v6
    v_add_u32 v30, v5, v6
    v_xor_b32 v6, 8, v4
    v_xor_b32 v6, v6, v3
    v_lshlrev_b32 v6, 4, v6
    v_add_u32 v31, v5, v6
    v_lshlrev_b32 v14, 4, v1
    s_lshl_b32 s50, s44, 22
    s_lshl_b32 s51, s48, 12
    s_lshl_b32 s52, s45, 19
    s_add_u32 s52, s52, s51
    s_mov_b32 s53, s52
    s_mov_b32 s30, 0x400000
    s_mov_b32 s31, 0x00020000
    s_waitcnt lgkmcnt(0)
    s_add_u32 s28, s6, s50
    s_addc_u32 s29, s7, 0
    s_add_u32 m0, s49, 0
    s_nop 0
    buffer_load_dwordx4 v10, s[28:31], s52 offen offset:0 nt lds
    buffer_load_dwordx4 v11, s[28:31], s52 offen offset:1024 nt lds
    buffer_load_dwordx4 v12, s[28:31], s52 offen offset:2048 nt lds
    buffer_load_dwordx4 v13, s[28:31], s52 offen offset:3072 nt lds
    s_add_u32 s52, s52, 16384
    s_add_u32 m0, s49, 4096
    s_nop 0
    buffer_load_dwordx4 v10, s[28:31], s52 offen offset:0 nt lds
    buffer_load_dwordx4 v11, s[28:31], s52 offen offset:1024 nt lds
    buffer_load_dwordx4 v12, s[28:31], s52 offen offset:2048 nt lds
    buffer_load_dwordx4 v13, s[28:31], s52 offen offset:3072 nt lds
    s_add_u32 s52, s52, 16384
    s_add_u32 s32, s8, s50
    s_addc_u32 s33, s9, 0
    s_mov_b32 s34, 0x400000
    s_mov_b32 s35, 0x00020000
    v_mov_b32 v9, 151040
    s_barrier
    s_add_u32 m0, s49, 8192
    s_nop 0
    buffer_load_dwordx4 v10, s[28:31], s52 offen offset:0 nt lds
    buffer_load_dwordx4 v11, s[28:31], s52 offen offset:1024 nt lds
    buffer_load_dwordx4 v12, s[28:31], s52 offen offset:2048 nt lds
    buffer_load_dwordx4 v13, s[28:31], s52 offen offset:3072 nt lds
    s_add_u32 s52, s52, 16384
    s_add_u32 m0, s49, 12288
    s_nop 0
    buffer_load_dwordx4 v10, s[28:31], s52 offen offset:0 nt lds
    buffer_load_dwordx4 v11, s[28:31], s52 offen offset:1024 nt lds
    buffer_load_dwordx4 v12, s[28:31], s52 offen offset:2048 nt lds
    buffer_load_dwordx4 v13, s[28:31], s52 offen offset:3072 nt lds
    s_add_u32 s52, s52, 16384
    s_add_u32 m0, s49, 16384
    s_nop 0
    buffer_load_dwordx4 v10, s[28:31], s52 offen offset:0 nt lds
    buffer_load_dwordx4 v11, s[28:31], s52 offen offset:1024 nt lds
    buffer_load_dwordx4 v12, s[28:31], s52 offen offset:2048 nt lds
    buffer_load_dwordx4 v13, s[28:31], s52 offen offset:3072 nt lds
    s_add_u32 s52, s52, 16384
    s_add_u32 m0, s49, 20480
    s_nop 0
    buffer_load_dwordx4 v10, s[28:31], s52 offen offset:0 nt lds
    buffer_load_dwordx4 v11, s[28:31], s52 offen offset:1024 nt lds
    buffer_load_dwordx4 v12, s[28:31], s52 offen offset:2048 nt lds
    buffer_load_dwordx4 v13, s[28:31], s52 offen offset:3072 nt lds
    s_add_u32 s52, s52, 16384
    s_add_u32 m0, s49, 24576
    s_nop 0
    buffer_load_dwordx4 v10, s[28:31], s52 offen offset:0 nt lds
    buffer_load_dwordx4 v11, s[28:31], s52 offen offset:1024 nt lds
    buffer_load_dwordx4 v12, s[28:31], s52 offen offset:2048 nt lds
    buffer_load_dwordx4 v13, s[28:31], s52 offen offset:3072 nt lds
    s_add_u32 s52, s52, 16384
    s_add_u32 m0, s49, 28672
    s_nop 0
    buffer_load_dwordx4 v10, s[28:31], s52 offen offset:0 nt lds
    buffer_load_dwordx4 v11, s[28:31], s52 offen offset:1024 nt lds
    buffer_load_dwordx4 v12, s[28:31], s52 offen offset:2048 nt lds
    buffer_load_dwordx4 v13, s[28:31], s52 offen offset:3072 nt lds
    s_add_u32 s52, s52, 16384
    s_mov_b32 s40, s12
    s_mov_b32 s41, s13
    s_mov_b32 s42, 3670016
    s_mov_b32 s43, 0x00020000
    s_lshl_b32 s55, s47, 9
    s_lshl_b32 s56, s45, 6
    s_add_u32 s55, s55, s56
    s_lshl_b32 s56, s48, 4
    s_add_u32 s55, s55, s56
    s_mul_i32 s55, s55, 896
    s_mov_b32 exec_hi, 0x00ffffff
    buffer_load_dwordx4 v[176:179], v14, s[40:43], s55 offen
    s_add_u32 s55, s55, 896
    buffer_load_dwordx4 v[180:183], v14, s[40:43], s55 offen
    s_add_u32 s55, s55, 896
    buffer_load_dwordx4 v[184:187], v14, s[40:43], s55 offen
    s_add_u32 s55, s55, 896
    buffer_load_dwordx4 v[188:191], v14, s[40:43], s55 offen
    s_add_u32 s55, s55, 896
    buffer_load_dwordx4 v[192:195], v14, s[40:43], s55 offen
    s_add_u32 s55, s55, 896
    buffer_load_dwordx4 v[196:199], v14, s[40:43], s55 offen
    s_add_u32 s55, s55, 896
    buffer_load_dwordx4 v[200:203], v14, s[40:43], s55 offen
    s_add_u32 s55, s55, 896
    buffer_load_dwordx4 v[204:207], v14, s[40:43], s55 offen
    s_add_u32 s55, s55, 896
    buffer_load_dwordx4 v[208:211], v14, s[40:43], s55 offen
    s_add_u32 s55, s55, 896
    buffer_load_dwordx4 v[212:215], v14, s[40:43], s55 offen
    s_add_u32 s55, s55, 896
    buffer_load_dwordx4 v[216:219], v14, s[40:43], s55 offen
    s_add_u32 s55, s55, 896
    buffer_load_dwordx4 v[220:223], v14, s[40:43], s55 offen
    s_add_u32 s55, s55, 896
    buffer_load_dwordx4 v[224:227], v14, s[40:43], s55 offen
    s_add_u32 s55, s55, 896
    buffer_load_dwordx4 v[228:231], v14, s[40:43], s55 offen
    s_add_u32 s55, s55, 896
    buffer_load_dwordx4 v[232:235], v14, s[40:43], s55 offen
    s_add_u32 s55, s55, 896
    buffer_load_dwordx4 v[236:239], v14, s[40:43], s55 offen
    s_mov_b64 exec, -1
    s_mov_b32 s36, s26
    s_mov_b32 s37, s27
    s_mov_b32 s38, 2359296
    s_mov_b32 s39, 0x00020000
    v_and_b32 v2, 15, v1
    v_lshrrev_b32 v3, 4, v1
    v_lshrrev_b32 v4, 3, v2
    v_and_b32 v5, 7, v2
    v_lshlrev_b32 v6, 12, v4
    v_lshlrev_b32 v7, 9, v5
    v_add_u32 v6, v6, v7
    v_add_u32 v6, s49, v6
    v_and_b32 v7, 1, v5
    v_lshlrev_b32 v7, 1, v7
    v_xor_b32 v7, v7, v3
    v_lshlrev_b32 v7, 4, v7
    v_add_u32 v6, v6, v7
    v_lshrrev_b32 v8, 1, v5
    v_xor_b32 v7, 0, v8
    v_lshlrev_b32 v7, 6, v7
    v_add_u32 v16, v6, v7
    v_xor_b32 v7, 1, v8
    v_lshlrev_b32 v7, 6, v7
    v_add_u32 v17, v6, v7
    v_xor_b32 v7, 2, v8
    v_lshlrev_b32 v7, 6, v7
    v_add_u32 v18, v6, v7
    v_xor_b32 v7, 3, v8
    v_lshlrev_b32 v7, 6, v7
    v_add_u32 v19, v6, v7
    v_bfe_u32 v5, v1, 2, 2
    v_lshrrev_b32 v2, 4, v1
    v_lshlrev_b32 v2, 1, v2
    v_bfe_u32 v3, v1, 1, 1
    v_add_u32 v2, v2, v3
    v_lshlrev_b32 v4, 2, v5
    v_lshlrev_b32 v6, 9, v5
    v_and_b32 v7, 1, v1
    v_lshlrev_b32 v7, 3, v7
    v_add_u32 v6, v6, v7
    v_add_u32 v6, s49, v6
    v_add_u32 v7, 0, v2
    v_xor_b32 v7, v7, v4
    v_lshlrev_b32 v7, 4, v7
    v_add_u32 v20, v6, v7
    v_add_u32 v7, 8, v2
    v_xor_b32 v7, v7, v4
    v_lshlrev_b32 v7, 4, v7
    v_add_u32 v21, v6, v7
    v_add_u32 v15, s49, v14
    s_xor_b32 s56, s60, 3
    s_add_u32 s56, s56, s47
    s_and_b32 s56, s56, 7
    s_lshl_b32 s68, s56, 19
    s_add_u32 s68, s68, s51
    s_add_u32 s68, s68, 491520
    s_mov_b32 s64, 1
    s_mov_b32 s65, 1
    s_mov_b32 s66, 1
    s_mov_b32 s67, 1
    s_mov_b32 s70, 0
    s_mov_b32 s71, 0
    s_mov_b32 s72, 0
    s_mov_b32 s73, 0
    s_mov_b32 s96, 800000
L_lw_1:
    ds_read_b32 v2, v9 offset:12
    s_waitcnt lgkmcnt(0)
    v_readfirstlane_b32 s56, v2
    s_sub_u32 s96, s96, 1
    s_cbranch_scc1 L_lwd_2
    s_cmp_ge_u32 s56, 4
    s_cbranch_scc0 L_lw_1
L_lwd_2:
    v_and_b32 v2, 1, v1
    v_lshlrev_b32 v2, 9, v2
    v_lshrrev_b32 v3, 4, v1
    v_lshlrev_b32 v3, 4, v3
    v_add_u32 v2, v2, v3
    v_add_u32 v2, 150016, v2
    ds_read_b128 v[32:35], v2 offset:0
    ds_read_b128 v[36:39], v2 offset:64
    ds_read_b128 v[40:43], v2 offset:128
    ds_read_b128 v[44:47], v2 offset:192
    ds_read_b128 v[48:51], v2 offset:256
    ds_read_b128 v[52:55], v2 offset:320
    ds_read_b128 v[56:59], v2 offset:384
    ds_read_b128 v[60:63], v2 offset:448
    v_mov_b32 v240, 0xff800000
    s_waitcnt vmcnt(40)
    ds_read_b128 v[64:67], v16 offset:0
    ds_read_b128 v[68:71], v17 offset:0
    ds_read_b128 v[72:75], v18 offset:0
    ds_read_b128 v[76:79], v19 offset:0
    ds_read_b128 v[80:83], v16 offset:256
    ds_read_b128 v[84:87], v17 offset:256
    ds_read_b128 v[88:91], v18 offset:256
    ds_read_b128 v[92:95], v19 offset:256
    s_waitcnt lgkmcnt(0)
    s_add_u32 m0, s49, 0
    s_nop 0
    buffer_load_dwordx4 v10, s[28:31], s52 offen offset:0 nt lds
    buffer_load_dwordx4 v11, s[28:31], s52 offen offset:1024 nt lds
    buffer_load_dwordx4 v12, s[28:31], s52 offen offset:2048 nt lds
    buffer_load_dwordx4 v13, s[28:31], s52 offen offset:3072 nt lds
    s_add_u32 s52, s52, 16384
    s_add_u32 m0, s49, 4096
    s_nop 0
    buffer_load_dwordx4 v10, s[28:31], s52 offen offset:0 nt lds
    buffer_load_dwordx4 v11, s[28:31], s52 offen offset:1024 nt lds
    buffer_load_dwordx4 v12, s[28:31], s52 offen offset:2048 nt lds
    buffer_load_dwordx4 v13, s[28:31], s52 offen offset:3072 nt lds
    s_add_u32 s52, s52, 16384
    v_mfma_f32_16x16x32_bf16 v[96:99], v[64:67], v[32:35], 0
    v_mfma_f32_16x16x32_bf16 v[96:99], v[68:71], v[36:39], v[96:99]
    v_mfma_f32_16x16x32_bf16 v[96:99], v[72:75], v[40:43], v[96:99]
    v_mfma_f32_16x16x32_bf16 v[96:99], v[76:79], v[44:47], v[96:99]
    v_mfma_f32_16x16x32_bf16 v[96:99], v[80:83], v[48:51], v[96:99]
    v_mfma_f32_16x16x32_bf16 v[96:99], v[84:87], v[52:55], v[96:99]
    v_mfma_f32_16x16x32_bf16 v[96:99], v[88:91], v[56:59], v[96:99]
    v_mfma_f32_16x16x32_bf16 v[96:99], v[92:95], v[60:63], v[96:99]
    s_waitcnt vmcnt(40)
    ds_read_b128 v[64:67], v16 offset:8192
    ds_read_b128 v[68:71], v17 offset:8192
    ds_read_b128 v[72:75], v18 offset:8192
    ds_read_b128 v[76:79], v19 offset:8192
    ds_read_b128 v[80:83], v16 offset:8448
    ds_read_b128 v[84:87], v17 offset:8448
    ds_read_b128 v[88:91], v18 offset:8448
    ds_read_b128 v[92:95], v19 offset:8448
    s_waitcnt lgkmcnt(0)
    s_add_u32 m0, s49, 8192
    s_nop 0
    buffer_load_dwordx4 v10, s[28:31], s52 offen offset:0 nt lds
    buffer_load_dwordx4 v11, s[28:31], s52 offen offset:1024 nt lds
    buffer_load_dwordx4 v12, s[28:31], s52 offen offset:2048 nt lds
    buffer_load_dwordx4 v13, s[28:31], s52 offen offset:3072 nt lds
    s_add_u32 s52, s52, 16384
    s_add_u32 m0, s49, 12288
    s_nop 0
    buffer_load_dwordx4 v10, s[28:31], s52 offen offset:0 nt lds
    buffer_load_dwordx4 v11, s[28:31], s52 offen offset:1024 nt lds
    buffer_load_dwordx4 v12, s[28:31], s52 offen offset:2048 nt lds
    buffer_load_dwordx4 v13, s[28:31], s52 offen offset:3072 nt lds
    s_add_u32 s52, s52, 16384
    v_mfma_f32_16x16x32_bf16 v[100:103], v[64:67], v[32:35], 0
    v_mfma_f32_16x16x32_bf16 v[100:103], v[68:71], v[36:39], v[100:103]
    v_mfma_f32_16x16x32_bf16 v[100:103], v[72:75], v[40:43], v[100:103]
    v_mfma_f32_16x16x32_bf16 v[100:103], v[76:79], v[44:47], v[100:103]
    v_mfma_f32_16x16x32_bf16 v[100:103], v[80:83], v[48:51], v[100:103]
    v_mfma_f32_16x16x32_bf16 v[100:103], v[84:87], v[52:55], v[100:103]
    v_mfma_f32_16x16x32_bf16 v[100:103], v[88:91], v[56:59], v[100:103]
    v_mfma_f32_16x16x32_bf16 v[100:103], v[92:95], v[60:63], v[100:103]
    v_cvt_pk_bf16_f32 v2, v96, v97
    v_cvt_pk_bf16_f32 v3, v98, v99
    v_lshlrev_b32 v96, 16, v2
    v_and_b32 v97, 0xffff0000, v2
    v_lshlrev_b32 v98, 16, v3
    v_and_b32 v99, 0xffff0000, v3
    v_max3_f32 v240, v240, v96, v97
    v_max3_f32 v240, v240, v98, v99
    s_waitcnt vmcnt(40)
    ds_read_b128 v[64:67], v16 offset:16384
    ds_read_b128 v[68:71], v17 offset:16384
    ds_read_b128 v[72:75], v18 offset:16384
    ds_read_b128 v[76:79], v19 offset:16384
    ds_read_b128 v[80:83], v16 offset:16640
    ds_read_b128 v[84:87], v17 offset:16640
    ds_read_b128 v[88:91], v18 offset:16640
    ds_read_b128 v[92:95], v19 offset:16640
    s_waitcnt lgkmcnt(0)
    s_add_u32 m0, s49, 16384
    s_nop 0
    buffer_load_dwordx4 v10, s[28:31], s52 offen offset:0 nt lds
    buffer_load_dwordx4 v11, s[28:31], s52 offen offset:1024 nt lds
    buffer_load_dwordx4 v12, s[28:31], s52 offen offset:2048 nt lds
    buffer_load_dwordx4 v13, s[28:31], s52 offen offset:3072 nt lds
    s_add_u32 s52, s52, 16384
    s_add_u32 m0, s49, 20480
    s_nop 0
    buffer_load_dwordx4 v10, s[28:31], s52 offen offset:0 nt lds
    buffer_load_dwordx4 v11, s[28:31], s52 offen offset:1024 nt lds
    buffer_load_dwordx4 v12, s[28:31], s52 offen offset:2048 nt lds
    buffer_load_dwordx4 v13, s[28:31], s52 offen offset:3072 nt lds
    s_add_u32 s52, s52, 16384
    v_mfma_f32_16x16x32_bf16 v[104:107], v[64:67], v[32:35], 0
    v_mfma_f32_16x16x32_bf16 v[104:107], v[68:71], v[36:39], v[104:107]
    v_mfma_f32_16x16x32_bf16 v[104:107], v[72:75], v[40:43], v[104:107]
    v_mfma_f32_16x16x32_bf16 v[104:107], v[76:79], v[44:47], v[104:107]
    v_mfma_f32_16x16x32_bf16 v[104:107], v[80:83], v[48:51], v[104:107]
    v_mfma_f32_16x16x32_bf16 v[104:107], v[84:87], v[52:55], v[104:107]
    v_mfma_f32_16x16x32_bf16 v[104:107], v[88:91], v[56:59], v[104:107]
    v_mfma_f32_16x16x32_bf16 v[104:107], v[92:95], v[60:63], v[104:107]
    v_cvt_pk_bf16_f32 v2, v100, v101
    v_cvt_pk_bf16_f32 v3, v102, v103
    v_lshlrev_b32 v100, 16, v2
    v_and_b32 v101, 0xffff0000, v2
    v_lshlrev_b32 v102, 16, v3
    v_and_b32 v103, 0xffff0000, v3
    v_max3_f32 v240, v240, v100, v101
    v_max3_f32 v240, v240, v102, v103
    s_waitcnt vmcnt(40)
    ds_read_b128 v[64:67], v16 offset:24576
    ds_read_b128 v[68:71], v17 offset:24576
    ds_read_b128 v[72:75], v18 offset:24576
    ds_read_b128 v[76:79], v19 offset:24576
    ds_read_b128 v[80:83], v16 offset:24832
    ds_read_b128 v[84:87], v17 offset:24832
    ds_read_b128 v[88:91], v18 offset:24832
    ds_read_b128 v[92:95], v19 offset:24832
    s_waitcnt lgkmcnt(0)
    s_add_u32 m0, s49, 24576
    s_nop 0
    buffer_load_dwordx4 v10, s[28:31], s52 offen offset:0 nt lds
    buffer_load_dwordx4 v11, s[28:31], s52 offen offset:1024 nt lds
    buffer_load_dwordx4 v12, s[28:31], s52 offen offset:2048 nt lds
    buffer_load_dwordx4 v13, s[28:31], s52 offen offset:3072 nt lds
    s_add_u32 s52, s52, 16384
    s_add_u32 m0, s49, 28672
    s_nop 0
    buffer_load_dwordx4 v10, s[28:31], s52 offen offset:0 nt lds
    buffer_load_dwordx4 v11, s[28:31], s52 offen offset:1024 nt lds
    buffer_load_dwordx4 v12, s[28:31], s52 offen offset:2048 nt lds
    buffer_load_dwordx4 v13, s[28:31], s52 offen offset:3072 nt lds
    s_add_u32 s52, s52, 16384
    v_mfma_f32_16x16x32_bf16 v[108:111], v[64:67], v[32:35], 0
    v_mfma_f32_16x16x32_bf16 v[108:111], v[68:71], v[36:39], v[108:111]
    v_mfma_f32_16x16x32_bf16 v[108:111], v[72:75], v[40:43], v[108:111]
    v_mfma_f32_16x16x32_bf16 v[108:111], v[76:79], v[44:47], v[108:111]
    v_mfma_f32_16x16x32_bf16 v[108:111], v[80:83], v[48:51], v[108:111]
    v_mfma_f32_16x16x32_bf16 v[108:111], v[84:87], v[52:55], v[108:111]
    v_mfma_f32_16x16x32_bf16 v[108:111], v[88:91], v[56:59], v[108:111]
    v_mfma_f32_16x16x32_bf16 v[108:111], v[92:95], v[60:63], v[108:111]
    v_cvt_pk_bf16_f32 v2, v104, v105
    v_cvt_pk_bf16_f32 v3, v106, v107
    v_lshlrev_b32 v104, 16, v2
    v_and_b32 v105, 0xffff0000, v2
    v_lshlrev_b32 v106, 16, v3
    v_and_b32 v107, 0xffff0000, v3
    v_max3_f32 v240, v240, v104, v105
    v_max3_f32 v240, v240, v106, v107
    s_waitcnt vmcnt(24)
    ds_read_b128 v[64:67], v16 offset:0
    ds_read_b128 v[68:71], v17 offset:0
    ds_read_b128 v[72:75], v18 offset:0
    ds_read_b128 v[76:79], v19 offset:0
    ds_read_b128 v[80:83], v16 offset:256
    ds_read_b128 v[84:87], v17 offset:256
    ds_read_b128 v[88:91], v18 offset:256
    ds_read_b128 v[92:95], v19 offset:256
    s_waitcnt lgkmcnt(0)
    s_add_u32 m0, s49, 0
    s_nop 0
    buffer_load_dwordx4 v10, s[28:31], s52 offen offset:0 nt lds
    buffer_load_dwordx4 v11, s[28:31], s52 offen offset:1024 nt lds
    buffer_load_dwordx4 v12, s[28:31], s52 offen offset:2048 nt lds
    buffer_load_dwordx4 v13, s[28:31], s52 offen offset:3072 nt lds
    s_add_u32 s52, s52, 16384
    s_add_u32 m0, s49, 4096
    s_nop 0
    buffer_load_dwordx4 v10, s[28:31], s52 offen offset:0 nt lds
    buffer_load_dwordx4 v11, s[28:31], s52 offen offset:1024 nt lds
    buffer_load_dwordx4 v12, s[28:31], s52 offen offset:2048 nt lds
    buffer_load_dwordx4 v13, s[28:31], s52 offen offset:3072 nt lds
    s_add_u32 s52, s52, 16384
    v_mfma_f32_16x16x32_bf16 v[112:115], v[64:67], v[32:35], 0
    v_mfma_f32_16x16x32_bf16 v[112:115], v[68:71], v[36:39], v[112:115]
    v_mfma_f32_16x16x32_bf16 v[112:115], v[72:75], v[40:43], v[112:115]
    v_mfma_f32_16x16x32_bf16 v[112:115], v[76:79], v[44:47], v[112:115]
    v_mfma_f32_16x16x32_bf16 v[112:115], v[80:83], v[48:51], v[112:115]
    v_mfma_f32_16x16x32_bf16 v[112:115], v[84:87], v[52:55], v[112:115]
    v_mfma_f32_16x16x32_bf16 v[112:115], v[88:91], v[56:59], v[112:115]
    v_mfma_f32_16x16x32_bf16 v[112:115], v[92:95], v[60:63], v[112:115]
    v_cvt_pk_bf16_f32 v2, v108, v109
    v_cvt_pk_bf16_f32 v3, v110, v111
    v_lshlrev_b32 v108, 16, v2
    v_and_b32 v109, 0xffff0000, v2
    v_lshlrev_b32 v110, 16, v3
    v_and_b32 v111, 0xffff0000, v3
    v_max3_f32 v240, v240, v108, v109
    v_max3_f32 v240, v240, v110, v111
    s_waitcnt vmcnt(24)
    ds_read_b128 v[64:67], v16 offset:8192
    ds_read_b128 v[68:71], v17 offset:8192
    ds_read_b128 v[72:75], v18 offset:8192
    ds_read_b128 v[76:79], v19 offset:8192
    ds_read_b128 v[80:83], v16 offset:8448
    ds_read_b128 v[84:87], v17 offset:8448
    ds_read_b128 v[88:91], v18 offset:8448
    ds_read_b128 v[92:95], v19 offset:8448
    s_waitcnt lgkmcnt(0)
    s_add_u32 m0, s49, 8192
    s_nop 0
    buffer_load_dwordx4 v10, s[28:31], s52 offen offset:0 nt lds
    buffer_load_dwordx4 v11, s[28:31], s52 offen offset:1024 nt lds
    buffer_load_dwordx4 v12, s[28:31], s52 offen offset:2048 nt lds
    buffer_load_dwordx4 v13, s[28:31], s52 offen offset:3072 nt lds
    s_add_u32 s52, s52, 16384
    s_add_u32 m0, s49, 12288
    s_nop 0
    buffer_load_dwordx4 v10, s[28:31], s52 offen offset:0 nt lds
    buffer_load_dwordx4 v11, s[28:31], s52 offen offset:1024 nt lds
    buffer_load_dwordx4 v12, s[28:31], s52 offen offset:2048 nt lds
    buffer_load_dwordx4 v13, s[28:31], s52 offen offset:3072 nt lds
    s_add_u32 s52, s52, 16384
    v_mfma_f32_16x16x32_bf16 v[116:119], v[64:67], v[32:35], 0
    v_mfma_f32_16x16x32_bf16 v[116:119], v[68:71], v[36:39], v[116:119]
    v_mfma_f32_16x16x32_bf16 v[116:119], v[72:75], v[40:43], v[116:119]
    v_mfma_f32_16x16x32_bf16 v[116:119], v[76:79], v[44:47], v[116:119]
    v_mfma_f32_16x16x32_bf16 v[116:119], v[80:83], v[48:51], v[116:119]
    v_mfma_f32_16x16x32_bf16 v[116:119], v[84:87], v[52:55], v[116:119]
    v_mfma_f32_16x16x32_bf16 v[116:119], v[88:91], v[56:59], v[116:119]
    v_mfma_f32_16x16x32_bf16 v[116:119], v[92:95], v[60:63], v[116:119]
    v_cvt_pk_bf16_f32 v2, v112, v113
    v_cvt_pk_bf16_f32 v3, v114, v115
    v_lshlrev_b32 v112, 16, v2
    v_and_b32 v113, 0xffff0000, v2
    v_lshlrev_b32 v114, 16, v3
    v_and_b32 v115, 0xffff0000, v3
    v_max3_f32 v240, v240, v112, v113
    v_max3_f32 v240, v240, v114, v115
    s_waitcnt vmcnt(24)
    ds_read_b128 v[64:67], v16 offset:16384
    ds_read_b128 v[68:71], v17 offset:16384
    ds_read_b128 v[72:75], v18 offset:16384
    ds_read_b128 v[76:79], v19 offset:16384
    ds_read_b128 v[80:83], v16 offset:16640
    ds_read_b128 v[84:87], v17 offset:16640
    ds_read_b128 v[88:91], v18 offset:16640
    ds_read_b128 v[92:95], v19 offset:16640
    s_waitcnt lgkmcnt(0)
    s_add_u32 m0, s49, 16384
    s_nop 0
    buffer_load_dwordx4 v10, s[28:31], s52 offen offset:0 nt lds
    buffer_load_dwordx4 v11, s[28:31], s52 offen offset:1024 nt lds
    buffer_load_dwordx4 v12, s[28:31], s52 offen offset:2048 nt lds
    buffer_load_dwordx4 v13, s[28:31], s52 offen offset:3072 nt lds
    s_add_u32 s52, s52, 16384
    s_add_u32 m0, s49, 20480
    s_nop 0
    buffer_load_dwordx4 v10, s[28:31], s52 offen offset:0 nt lds
    buffer_load_dwordx4 v11, s[28:31], s52 offen offset:1024 nt lds
    buffer_load_dwordx4 v12, s[28:31], s52 offen offset:2048 nt lds
    buffer_load_dwordx4 v13, s[28:31], s52 offen offset:3072 nt lds
    s_add_u32 s52, s52, 16384
    v_mfma_f32_16x16x32_bf16 v[120:123], v[64:67], v[32:35], 0
    v_mfma_f32_16x16x32_bf16 v[120:123], v[68:71], v[36:39], v[120:123]
    v_mfma_f32_16x16x32_bf16 v[120:123], v[72:75], v[40:43], v[120:123]
    v_mfma_f32_16x16x32_bf16 v[120:123], v[76:79], v[44:47], v[120:123]
    v_mfma_f32_16x16x32_bf16 v[120:123], v[80:83], v[48:51], v[120:123]
    v_mfma_f32_16x16x32_bf16 v[120:123], v[84:87], v[52:55], v[120:123]
    v_mfma_f32_16x16x32_bf16 v[120:123], v[88:91], v[56:59], v[120:123]
    v_mfma_f32_16x16x32_bf16 v[120:123], v[92:95], v[60:63], v[120:123]
    v_cvt_pk_bf16_f32 v2, v116, v117
    v_cvt_pk_bf16_f32 v3, v118, v119
    v_lshlrev_b32 v116, 16, v2
    v_and_b32 v117, 0xffff0000, v2
    v_lshlrev_b32 v118, 16, v3
    v_and_b32 v119, 0xffff0000, v3
    v_max3_f32 v240, v240, v116, v117
    v_max3_f32 v240, v240, v118, v119
    s_waitcnt vmcnt(24)
    ds_read_b128 v[64:67], v16 offset:24576
    ds_read_b128 v[68:71], v17 offset:24576
    ds_read_b128 v[72:75], v18 offset:24576
    ds_read_b128 v[76:79], v19 offset:24576
    ds_read_b128 v[80:83], v16 offset:24832
    ds_read_b128 v[84:87], v17 offset:24832
    ds_read_b128 v[88:91], v18 offset:24832
    ds_read_b128 v[92:95], v19 offset:24832
    s_waitcnt lgkmcnt(0)
    s_add_u32 m0, s49, 24576
    s_nop 0
    buffer_load_dwordx4 v10, s[28:31], s52 offen offset:0 nt lds
    buffer_load_dwordx4 v11, s[28:31], s52 offen offset:1024 nt lds
    buffer_load_dwordx4 v12, s[28:31], s52 offen offset:2048 nt lds
    buffer_load_dwordx4 v13, s[28:31], s52 offen offset:3072 nt lds
    s_add_u32 s52, s52, 16384
    s_add_u32 m0, s49, 28672
    s_nop 0
    buffer_load_dwordx4 v10, s[28:31], s52 offen offset:0 nt lds
    buffer_load_dwordx4 v11, s[28:31], s52 offen offset:1024 nt lds
    buffer_load_dwordx4 v12, s[28:31], s52 offen offset:2048 nt lds
    buffer_load_dwordx4 v13, s[28:31], s52 offen offset:3072 nt lds
    s_add_u32 s52, s52, 16384
    v_mfma_f32_16x16x32_bf16 v[124:127], v[64:67], v[32:35], 0
    v_mfma_f32_16x16x32_bf16 v[124:127], v[68:71], v[36:39], v[124:127]
    v_mfma_f32_16x16x32_bf16 v[124:127], v[72:75], v[40:43], v[124:127]
    v_mfma_f32_16x16x32_bf16 v[124:127], v[76:79], v[44:47], v[124:127]
    v_mfma_f32_16x16x32_bf16 v[124:127], v[80:83], v[48:51], v[124:127]
    v_mfma_f32_16x16x32_bf16 v[124:127], v[84:87], v[52:55], v[124:127]
    v_mfma_f32_16x16x32_bf16 v[124:127], v[88:91], v[56:59], v[124:127]
    v_mfma_f32_16x16x32_bf16 v[124:127], v[92:95], v[60:63], v[124:127]
    v_cvt_pk_bf16_f32 v2, v120, v121
    v_cvt_pk_bf16_f32 v3, v122, v123
    v_lshlrev_b32 v120, 16, v2
    v_and_b32 v121, 0xffff0000, v2
    v_lshlrev_b32 v122, 16, v3
    v_and_b32 v123, 0xffff0000, v3
    v_max3_f32 v240, v240, v120, v121
    v_max3_f32 v240, v240, v122, v123
    s_waitcnt vmcnt(24)
    ds_read_b128 v[64:67], v16 offset:0
    ds_read_b128 v[68:71], v17 offset:0
    ds_read_b128 v[72:75], v18 offset:0
    ds_read_b128 v[76:79], v19 offset:0
    ds_read_b128 v[80:83], v16 offset:256
    ds_read_b128 v[84:87], v17 offset:256
    ds_read_b128 v[88:91], v18 offset:256
    ds_read_b128 v[92:95], v19 offset:256
    s_waitcnt lgkmcnt(0)
    s_add_u32 m0, s49, 0
    s_nop 0
    buffer_load_dwordx4 v10, s[28:31], s52 offen offset:0 nt lds
    buffer_load_dwordx4 v11, s[28:31], s52 offen offset:1024 nt lds
    buffer_load_dwordx4 v12, s[28:31], s52 offen offset:2048 nt lds
    buffer_load_dwordx4 v13, s[28:31], s52 offen offset:3072 nt lds
    s_add_u32 s52, s52, 16384
    s_add_u32 m0, s49, 4096
    s_nop 0
    buffer_load_dwordx4 v10, s[28:31], s52 offen offset:0 nt lds
    buffer_load_dwordx4 v11, s[28:31], s52 offen offset:1024 nt lds
    buffer_load_dwordx4 v12, s[28:31], s52 offen offset:2048 nt lds
    buffer_load_dwordx4 v13, s[28:31], s52 offen offset:3072 nt lds
    s_add_u32 s52, s52, 16384
    v_mfma_f32_16x16x32_bf16 v[128:131], v[64:67], v[32:35], 0
    v_mfma_f32_16x16x32_bf16 v[128:131], v[68:71], v[36:39], v[128:131]
    v_mfma_f32_16x16x32_bf16 v[128:131], v[72:75], v[40:43], v[128:131]
    v_mfma_f32_16x16x32_bf16 v[128:131], v[76:79], v[44:47], v[128:131]
    v_mfma_f32_16x16x32_bf16 v[128:131], v[80:83], v[48:51], v[128:131]
    v_mfma_f32_16x16x32_bf16 v[128:131], v[84:87], v[52:55], v[128:131]
    v_mfma_f32_16x16x32_bf16 v[128:131], v[88:91], v[56:59], v[128:131]
    v_mfma_f32_16x16x32_bf16 v[128:131], v[92:95], v[60:63], v[128:131]
    v_cvt_pk_bf16_f32 v2, v124, v125
    v_cvt_pk_bf16_f32 v3, v126, v127
    v_lshlrev_b32 v124, 16, v2
    v_and_b32 v125, 0xffff0000, v2
    v_lshlrev_b32 v126, 16, v3
    v_and_b32 v127, 0xffff0000, v3
    v_max3_f32 v240, v240, v124, v125
    v_max3_f32 v240, v240, v126, v127
    s_waitcnt vmcnt(24)
    ds_read_b128 v[64:67], v16 offset:8192
    ds_read_b128 v[68:71], v17 offset:8192
    ds_read_b128 v[72:75], v18 offset:8192
    ds_read_b128 v[76:79], v19 offset:8192
    ds_read_b128 v[80:83], v16 offset:8448
    ds_read_b128 v[84:87], v17 offset:8448
    ds_read_b128 v[88:91], v18 offset:8448
    ds_read_b128 v[92:95], v19 offset:8448
    s_waitcnt lgkmcnt(0)
    s_add_u32 m0, s49, 8192
    s_nop 0
    buffer_load_dwordx4 v10, s[28:31], s52 offen offset:0 nt lds
    buffer_load_dwordx4 v11, s[28:31], s52 offen offset:1024 nt lds
    buffer_load_dwordx4 v12, s[28:31], s52 offen offset:2048 nt lds
    buffer_load_dwordx4 v13, s[28:31], s52 offen offset:3072 nt lds
    s_add_u32 s52, s52, 16384
    s_add_u32 m0, s49, 12288
    s_nop 0
    buffer_load_dwordx4 v10, s[28:31], s52 offen offset:0 nt lds
    buffer_load_dwordx4 v11, s[28:31], s52 offen offset:1024 nt lds
    buffer_load_dwordx4 v12, s[28:31], s52 offen offset:2048 nt lds
    buffer_load_dwordx4 v13, s[28:31], s52 offen offset:3072 nt lds
    s_add_u32 s52, s52, 16384
    v_mfma_f32_16x16x32_bf16 v[132:135], v[64:67], v[32:35], 0
    v_mfma_f32_16x16x32_bf16 v[132:135], v[68:71], v[36:39], v[132:135]
    v_mfma_f32_16x16x32_bf16 v[132:135], v[72:75], v[40:43], v[132:135]
    v_mfma_f32_16x16x32_bf16 v[132:135], v[76:79], v[44:47], v[132:135]
    v_mfma_f32_16x16x32_bf16 v[132:135], v[80:83], v[48:51], v[132:135]
    v_mfma_f32_16x16x32_bf16 v[132:135], v[84:87], v[52:55], v[132:135]
    v_mfma_f32_16x16x32_bf16 v[132:135], v[88:91], v[56:59], v[132:135]
    v_mfma_f32_16x16x32_bf16 v[132:135], v[92:95], v[60:63], v[132:135]
    v_cvt_pk_bf16_f32 v2, v128, v129
    v_cvt_pk_bf16_f32 v3, v130, v131
    v_lshlrev_b32 v128, 16, v2
    v_and_b32 v129, 0xffff0000, v2
    v_lshlrev_b32 v130, 16, v3
    v_and_b32 v131, 0xffff0000, v3
    v_max3_f32 v240, v240, v128, v129
    v_max3_f32 v240, v240, v130, v131
    s_waitcnt vmcnt(24)
    ds_read_b128 v[64:67], v16 offset:16384
    ds_read_b128 v[68:71], v17 offset:16384
    ds_read_b128 v[72:75], v18 offset:16384
    ds_read_b128 v[76:79], v19 offset:16384
    ds_read_b128 v[80:83], v16 offset:16640
    ds_read_b128 v[84:87], v17 offset:16640
    ds_read_b128 v[88:91], v18 offset:16640
    ds_read_b128 v[92:95], v19 offset:16640
    s_waitcnt lgkmcnt(0)
    s_add_u32 m0, s49, 16384
    s_nop 0
    buffer_load_dwordx4 v10, s[28:31], s52 offen offset:0 nt lds
    buffer_load_dwordx4 v11, s[28:31], s52 offen offset:1024 nt lds
    buffer_load_dwordx4 v12, s[28:31], s52 offen offset:2048 nt lds
    buffer_load_dwordx4 v13, s[28:31], s52 offen offset:3072 nt lds
    s_add_u32 s52, s52, 16384
    s_add_u32 m0, s49, 20480
    s_nop 0
    buffer_load_dwordx4 v10, s[28:31], s52 offen offset:0 nt lds
    buffer_load_dwordx4 v11, s[28:31], s52 offen offset:1024 nt lds
    buffer_load_dwordx4 v12, s[28:31], s52 offen offset:2048 nt lds
    buffer_load_dwordx4 v13, s[28:31], s52 offen offset:3072 nt lds
    s_add_u32 s52, s52, 16384
    v_mfma_f32_16x16x32_bf16 v[136:139], v[64:67], v[32:35], 0
    v_mfma_f32_16x16x32_bf16 v[136:139], v[68:71], v[36:39], v[136:139]
    v_mfma_f32_16x16x32_bf16 v[136:139], v[72:75], v[40:43], v[136:139]
    v_mfma_f32_16x16x32_bf16 v[136:139], v[76:79], v[44:47], v[136:139]
    v_mfma_f32_16x16x32_bf16 v[136:139], v[80:83], v[48:51], v[136:139]
    v_mfma_f32_16x16x32_bf16 v[136:139], v[84:87], v[52:55], v[136:139]
    v_mfma_f32_16x16x32_bf16 v[136:139], v[88:91], v[56:59], v[136:139]
    v_mfma_f32_16x16x32_bf16 v[136:139], v[92:95], v[60:63], v[136:139]
    v_cvt_pk_bf16_f32 v2, v132, v133
    v_cvt_pk_bf16_f32 v3, v134, v135
    v_lshlrev_b32 v132, 16, v2
    v_and_b32 v133, 0xffff0000, v2
    v_lshlrev_b32 v134, 16, v3
    v_and_b32 v135, 0xffff0000, v3
    v_max3_f32 v240, v240, v132, v133
    v_max3_f32 v240, v240, v134, v135
    s_waitcnt vmcnt(24)
    ds_read_b128 v[64:67], v16 offset:24576
    ds_read_b128 v[68:71], v17 offset:24576
    ds_read_b128 v[72:75], v18 offset:24576
    ds_read_b128 v[76:79], v19 offset:24576
    ds_read_b128 v[80:83], v16 offset:24832
    ds_read_b128 v[84:87], v17 offset:24832
    ds_read_b128 v[88:91], v18 offset:24832
    ds_read_b128 v[92:95], v19 offset:24832
    s_waitcnt lgkmcnt(0)
    s_add_u32 m0, s49, 24576
    s_nop 0
    buffer_load_dwordx4 v10, s[28:31], s52 offen offset:0 nt lds
    buffer_load_dwordx4 v11, s[28:31], s52 offen offset:1024 nt lds
    buffer_load_dwordx4 v12, s[28:31], s52 offen offset:2048 nt lds
    buffer_load_dwordx4 v13, s[28:31], s52 offen offset:3072 nt lds
    s_add_u32 s52, s52, 16384
    s_add_u32 m0, s49, 28672
    s_nop 0
    buffer_load_dwordx4 v10, s[28:31], s52 offen offset:0 nt lds
    buffer_load_dwordx4 v11, s[28:31], s52 offen offset:1024 nt lds
    buffer_load_dwordx4 v12, s[28:31], s52 offen offset:2048 nt lds
    buffer_load_dwordx4 v13, s[28:31], s52 offen offset:3072 nt lds
    s_add_u32 s52, s52, 16384
    v_mfma_f32_16x16x32_bf16 v[140:143], v[64:67], v[32:35], 0
    v_mfma_f32_16x16x32_bf16 v[140:143], v[68:71], v[36:39], v[140:143]
    v_mfma_f32_16x16x32_bf16 v[140:143], v[72:75], v[40:43], v[140:143]
    v_mfma_f32_16x16x32_bf16 v[140:143], v[76:79], v[44:47], v[140:143]
    v_mfma_f32_16x16x32_bf16 v[140:143], v[80:83], v[48:51], v[140:143]
    v_mfma_f32_16x16x32_bf16 v[140:143], v[84:87], v[52:55], v[140:143]
    v_mfma_f32_16x16x32_bf16 v[140:143], v[88:91], v[56:59], v[140:143]
    v_mfma_f32_16x16x32_bf16 v[140:143], v[92:95], v[60:63], v[140:143]
    v_cvt_pk_bf16_f32 v2, v136, v137
    v_cvt_pk_bf16_f32 v3, v138, v139
    v_lshlrev_b32 v136, 16, v2
    v_and_b32 v137, 0xffff0000, v2
    v_lshlrev_b32 v138, 16, v3
    v_and_b32 v139, 0xffff0000, v3
    v_max3_f32 v240, v240, v136, v137
    v_max3_f32 v240, v240, v138, v139
    s_waitcnt vmcnt(24)
    ds_read_b128 v[64:67], v16 offset:0
    ds_read_b128 v[68:71], v17 offset:0
    ds_read_b128 v[72:75], v18 offset:0
    ds_read_b128 v[76:79], v19 offset:0
    ds_read_b128 v[80:83], v16 offset:256
    ds_read_b128 v[84:87], v17 offset:256
    ds_read_b128 v[88:91], v18 offset:256
    ds_read_b128 v[92:95], v19 offset:256
    s_waitcnt lgkmcnt(0)
    s_add_u32 m0, s49, 0
    s_nop 0
    buffer_load_dwordx4 v28, s[32:35], s53 offen offset:0 nt lds
    buffer_load_dwordx4 v29, s[32:35], s53 offen offset:1024 nt lds
    buffer_load_dwordx4 v30, s[32:35], s53 offen offset:2048 nt lds
    buffer_load_dwordx4 v31, s[32:35], s53 offen offset:3072 nt lds
    s_add_u32 s53, s53, 16384
    s_add_u32 m0, s49, 4096
    s_nop 0
    buffer_load_dwordx4 v28, s[32:35], s53 offen offset:0 nt lds
    buffer_load_dwordx4 v29, s[32:35], s53 offen offset:1024 nt lds
    buffer_load_dwordx4 v30, s[32:35], s53 offen offset:2048 nt lds
    buffer_load_dwordx4 v31, s[32:35], s53 offen offset:3072 nt lds
    s_add_u32 s53, s53, 16384
    v_mfma_f32_16x16x32_bf16 v[144:147], v[64:67], v[32:35], 0
    v_mfma_f32_16x16x32_bf16 v[144:147], v[68:71], v[36:39], v[144:147]
    v_mfma_f32_16x16x32_bf16 v[144:147], v[72:75], v[40:43], v[144:147]
    v_mfma_f32_16x16x32_bf16 v[144:147], v[76:79], v[44:47], v[144:147]
    v_mfma_f32_16x16x32_bf16 v[144:147], v[80:83], v[48:51], v[144:147]
    v_mfma_f32_16x16x32_bf16 v[144:147], v[84:87], v[52:55], v[144:147]
    v_mfma_f32_16x16x32_bf16 v[144:147], v[88:91], v[56:59], v[144:147]
    v_mfma_f32_16x16x32_bf16 v[144:147], v[92:95], v[60:63], v[144:147]
    v_cvt_pk_bf16_f32 v2, v140, v141
    v_cvt_pk_bf16_f32 v3, v142, v143
    v_lshlrev_b32 v140, 16, v2
    v_and_b32 v141, 0xffff0000, v2
    v_lshlrev_b32 v142, 16, v3
    v_and_b32 v143, 0xffff0000, v3
    v_max3_f32 v240, v240, v140, v141
    v_max3_f32 v240, v240, v142, v143
    s_waitcnt vmcnt(24)
    ds_read_b128 v[64:67], v16 offset:8192
    ds_read_b128 v[68:71], v17 offset:8192
    ds_read_b128 v[72:75], v18 offset:8192
    ds_read_b128 v[76:79], v19 offset:8192
    ds_read_b128 v[80:83], v16 offset:8448
    ds_read_b128 v[84:87], v17 offset:8448
    ds_read_b128 v[88:91], v18 offset:8448
    ds_read_b128 v[92:95], v19 offset:8448
    s_waitcnt lgkmcnt(0)
    s_add_u32 m0, s49, 8192
    s_nop 0
    buffer_load_dwordx4 v28, s[32:35], s53 offen offset:0 nt lds
    buffer_load_dwordx4 v29, s[32:35], s53 offen offset:1024 nt lds
    buffer_load_dwordx4 v30, s[32:35], s53 offen offset:2048 nt lds
    buffer_load_dwordx4 v31, s[32:35], s53 offen offset:3072 nt lds
    s_add_u32 s53, s53, 16384
    s_add_u32 m0, s49, 12288
    s_nop 0
    buffer_load_dwordx4 v28, s[32:35], s53 offen offset:0 nt lds
    buffer_load_dwordx4 v29, s[32:35], s53 offen offset:1024 nt lds
    buffer_load_dwordx4 v30, s[32:35], s53 offen offset:2048 nt lds
    buffer_load_dwordx4 v31, s[32:35], s53 offen offset:3072 nt lds
    s_add_u32 s53, s53, 16384
    v_mfma_f32_16x16x32_bf16 v[148:151], v[64:67], v[32:35], 0
    v_mfma_f32_16x16x32_bf16 v[148:151], v[68:71], v[36:39], v[148:151]
    v_mfma_f32_16x16x32_bf16 v[148:151], v[72:75], v[40:43], v[148:151]
    v_mfma_f32_16x16x32_bf16 v[148:151], v[76:79], v[44:47], v[148:151]
    v_mfma_f32_16x16x32_bf16 v[148:151], v[80:83], v[48:51], v[148:151]
    v_mfma_f32_16x16x32_bf16 v[148:151], v[84:87], v[52:55], v[148:151]
    v_mfma_f32_16x16x32_bf16 v[148:151], v[88:91], v[56:59], v[148:151]
    v_mfma_f32_16x16x32_bf16 v[148:151], v[92:95], v[60:63], v[148:151]
    v_cvt_pk_bf16_f32 v2, v144, v145
    v_cvt_pk_bf16_f32 v3, v146, v147
    v_lshlrev_b32 v144, 16, v2
    v_and_b32 v145, 0xffff0000, v2
    v_lshlrev_b32 v146, 16, v3
    v_and_b32 v147, 0xffff0000, v3
    v_max3_f32 v240, v240, v144, v145
    v_max3_f32 v240, v240, v146, v147
    s_waitcnt vmcnt(24)
    ds_read_b128 v[64:67], v16 offset:16384
    ds_read_b128 v[68:71], v17 offset:16384
    ds_read_b128 v[72:75], v18 offset:16384
    ds_read_b128 v[76:79], v19 offset:16384
    ds_read_b128 v[80:83], v16 offset:16640
    ds_read_b128 v[84:87], v17 offset:16640
    ds_read_b128 v[88:91], v18 offset:16640
    ds_read_b128 v[92:95], v19 offset:16640
    s_waitcnt lgkmcnt(0)
    s_add_u32 m0, s49, 16384
    s_nop 0
    buffer_load_dwordx4 v28, s[32:35], s53 offen offset:0 nt lds
    buffer_load_dwordx4 v29, s[32:35], s53 offen offset:1024 nt lds
    buffer_load_dwordx4 v30, s[32:35], s53 offen offset:2048 nt lds
    buffer_load_dwordx4 v31, s[32:35], s53 offen offset:3072 nt lds
    s_add_u32 s53, s53, 16384
    s_add_u32 m0, s49, 20480
    s_nop 0
    buffer_load_dwordx4 v28, s[32:35], s53 offen offset:0 nt lds
    buffer_load_dwordx4 v29, s[32:35], s53 offen offset:1024 nt lds
    buffer_load_dwordx4 v30, s[32:35], s53 offen offset:2048 nt lds
    buffer_load_dwordx4 v31, s[32:35], s53 offen offset:3072 nt lds
    s_add_u32 s53, s53, 16384
    v_mfma_f32_16x16x32_bf16 v[152:155], v[64:67], v[32:35], 0
    v_mfma_f32_16x16x32_bf16 v[152:155], v[68:71], v[36:39], v[152:155]
    v_mfma_f32_16x16x32_bf16 v[152:155], v[72:75], v[40:43], v[152:155]
    v_mfma_f32_16x16x32_bf16 v[152:155], v[76:79], v[44:47], v[152:155]
    v_mfma_f32_16x16x32_bf16 v[152:155], v[80:83], v[48:51], v[152:155]
    v_mfma_f32_16x16x32_bf16 v[152:155], v[84:87], v[52:55], v[152:155]
    v_mfma_f32_16x16x32_bf16 v[152:155], v[88:91], v[56:59], v[152:155]
    v_mfma_f32_16x16x32_bf16 v[152:155], v[92:95], v[60:63], v[152:155]
    v_cvt_pk_bf16_f32 v2, v148, v149
    v_cvt_pk_bf16_f32 v3, v150, v151
    v_lshlrev_b32 v148, 16, v2
    v_and_b32 v149, 0xffff0000, v2
    v_lshlrev_b32 v150, 16, v3
    v_and_b32 v151, 0xffff0000, v3
    v_max3_f32 v240, v240, v148, v149
    v_max3_f32 v240, v240, v150, v151
    s_waitcnt vmcnt(24)
    ds_read_b128 v[64:67], v16 offset:24576
    ds_read_b128 v[68:71], v17 offset:24576
    ds_read_b128 v[72:75], v18 offset:24576
    ds_read_b128 v[76:79], v19 offset:24576
    ds_read_b128 v[80:83], v16 offset:24832
    ds_read_b128 v[84:87], v17 offset:24832
    ds_read_b128 v[88:91], v18 offset:24832
    ds_read_b128 v[92:95], v19 offset:24832
    s_waitcnt lgkmcnt(0)
    s_add_u32 m0, s49, 24576
    s_nop 0
    buffer_load_dwordx4 v28, s[32:35], s53 offen offset:0 nt lds
    buffer_load_dwordx4 v29, s[32:35], s53 offen offset:1024 nt lds
    buffer_load_dwordx4 v30, s[32:35], s53 offen offset:2048 nt lds
    buffer_load_dwordx4 v31, s[32:35], s53 offen offset:3072 nt lds
    s_add_u32 s53, s53, 16384
    s_add_u32 m0, s49, 28672
    s_nop 0
    buffer_load_dwordx4 v28, s[32:35], s53 offen offset:0 nt lds
    buffer_load_dwordx4 v29, s[32:35], s53 offen offset:1024 nt lds
    buffer_load_dwordx4 v30, s[32:35], s53 offen offset:2048 nt lds
    buffer_load_dwordx4 v31, s[32:35], s53 offen offset:3072 nt lds
    s_add_u32 s53, s53, 16384
    v_mfma_f32_16x16x32_bf16 v[156:159], v[64:67], v[32:35], 0
    v_mfma_f32_16x16x32_bf16 v[156:159], v[68:71], v[36:39], v[156:159]
    v_mfma_f32_16x16x32_bf16 v[156:159], v[72:75], v[40:43], v[156:159]
    v_mfma_f32_16x16x32_bf16 v[156:159], v[76:79], v[44:47], v[156:159]
    v_mfma_f32_16x16x32_bf16 v[156:159], v[80:83], v[48:51], v[156:159]
    v_mfma_f32_16x16x32_bf16 v[156:159], v[84:87], v[52:55], v[156:159]
    v_mfma_f32_16x16x32_bf16 v[156:159], v[88:91], v[56:59], v[156:159]
    v_mfma_f32_16x16x32_bf16 v[156:159], v[92:95], v[60:63], v[156:159]
    v_cvt_pk_bf16_f32 v2, v152, v153
    v_cvt_pk_bf16_f32 v3, v154, v155
    v_lshlrev_b32 v152, 16, v2
    v_and_b32 v153, 0xffff0000, v2
    v_lshlrev_b32 v154, 16, v3
    v_and_b32 v155, 0xffff0000, v3
    v_max3_f32 v240, v240, v152, v153
    v_max3_f32 v240, v240, v154, v155
    s_nop 7
    v_cvt_pk_bf16_f32 v2, v156, v157
    v_cvt_pk_bf16_f32 v3, v158, v159
    v_lshlrev_b32 v156, 16, v2
    v_and_b32 v157, 0xffff0000, v2
    v_lshlrev_b32 v158, 16, v3
    v_and_b32 v159, 0xffff0000, v3
    v_max3_f32 v240, v240, v156, v157
    v_max3_f32 v240, v240, v158, v159
    s_mov_b64 exec, 1
    v_mov_b32 v2, 1
    ds_add_u32 v9, v2 offset:20
    s_mov_b64 exec, -1
    v_mov_b32 v2, v240
    s_nop 1
    v_permlane16_swap_b32 v240, v2
    s_nop 1
    v_max_f32 v240, v240, v2
    v_mov_b32 v2, v240
    s_nop 1
    v_permlane32_swap_b32 v240, v2
    s_nop 1
    v_max_f32 v240, v240, v2
    s_mov_b32 s56, 0x3db8aa3b
    v_mul_f32 v242, s56, v240
    v_mov_b32 v244, 0
    v_mov_b32 v245, 0
    v_fma_f32 v2, v96, s56, -v242
    v_fma_f32 v3, v97, s56, -v242
    v_fma_f32 v4, v98, s56, -v242
    v_fma_f32 v5, v99, s56, -v242
    v_exp_f32 v2, v2
    v_exp_f32 v3, v3
    v_exp_f32 v4, v4
    v_exp_f32 v5, v5
    s_nop 0
    v_add_f32 v244, v244, v2
    v_add_f32 v245, v245, v3
    v_add_f32 v244, v244, v4
    v_add_f32 v245, v245, v5
    v_cvt_pk_bf16_f32 v96, v2, v3
    v_cvt_pk_bf16_f32 v97, v4, v5
    v_fma_f32 v2, v100, s56, -v242
    v_fma_f32 v3, v101, s56, -v242
    v_fma_f32 v4, v102, s56, -v242
    v_fma_f32 v5, v103, s56, -v242
    v_exp_f32 v2, v2
    v_exp_f32 v3, v3
    v_exp_f32 v4, v4
    v_exp_f32 v5, v5
    s_nop 0
    v_add_f32 v244, v244, v2
    v_add_f32 v245, v245, v3
    v_add_f32 v244, v244, v4
    v_add_f32 v245, v245, v5
    v_cvt_pk_bf16_f32 v98, v2, v3
    v_cvt_pk_bf16_f32 v99, v4, v5
    v_fma_f32 v2, v104, s56, -v242
    v_fma_f32 v3, v105, s56, -v242
    v_fma_f32 v4, v106, s56, -v242
    v_fma_f32 v5, v107, s56, -v242
    v_exp_f32 v2, v2
    v_exp_f32 v3, v3
    v_exp_f32 v4, v4
    v_exp_f32 v5, v5
    s_nop 0
    v_add_f32 v244, v244, v2
    v_add_f32 v245, v245, v3
    v_add_f32 v244, v244, v4
    v_add_f32 v245, v245, v5
    v_cvt_pk_bf16_f32 v100, v2, v3
    v_cvt_pk_bf16_f32 v101, v4, v5
    v_fma_f32 v2, v108, s56, -v242
    v_fma_f32 v3, v109, s56, -v242
    v_fma_f32 v4, v110, s56, -v242
    v_fma_f32 v5, v111, s56, -v242
    v_exp_f32 v2, v2
    v_exp_f32 v3, v3
    v_exp_f32 v4, v4
    v_exp_f32 v5, v5
    s_nop 0
    v_add_f32 v244, v244, v2
    v_add_f32 v245, v245, v3
    v_add_f32 v244, v244, v4
    v_add_f32 v245, v245, v5
    v_cvt_pk_bf16_f32 v102, v2, v3
    v_cvt_pk_bf16_f32 v103, v4, v5
    v_fma_f32 v2, v112, s56, -v242
    v_fma_f32 v3, v113, s56, -v242
    v_fma_f32 v4, v114, s56, -v242
    v_fma_f32 v5, v115, s56, -v242
    v_exp_f32 v2, v2
    v_exp_f32 v3, v3
    v_exp_f32 v4, v4
    v_exp_f32 v5, v5
    s_nop 0
    v_add_f32 v244, v244, v2
    v_add_f32 v245, v245, v3
    v_add_f32 v244, v244, v4
    v_add_f32 v245, v245, v5
    v_cvt_pk_bf16_f32 v104, v2, v3
    v_cvt_pk_bf16_f32 v105, v4, v5
    v_fma_f32 v2, v116, s56, -v242
    v_fma_f32 v3, v117, s56, -v242
    v_fma_f32 v4, v118, s56, -v242
    v_fma_f32 v5, v119, s56, -v242
    v_exp_f32 v2, v2
    v_exp_f32 v3, v3
    v_exp_f32 v4, v4
    v_exp_f32 v5, v5
    s_nop 0
    v_add_f32 v244, v244, v2
    v_add_f32 v245, v245, v3
    v_add_f32 v244, v244, v4
    v_add_f32 v245, v245, v5
    v_cvt_pk_bf16_f32 v106, v2, v3
    v_cvt_pk_bf16_f32 v107, v4, v5
    v_fma_f32 v2, v120, s56, -v242
    v_fma_f32 v3, v121, s56, -v242
    v_fma_f32 v4, v122, s56, -v242
    v_fma_f32 v5, v123, s56, -v242
    v_exp_f32 v2, v2
    v_exp_f32 v3, v3
    v_exp_f32 v4, v4
    v_exp_f32 v5, v5
    s_nop 0
    v_add_f32 v244, v244, v2
    v_add_f32 v245, v245, v3
    v_add_f32 v244, v244, v4
    v_add_f32 v245, v245, v5
    v_cvt_pk_bf16_f32 v108, v2, v3
    v_cvt_pk_bf16_f32 v109, v4, v5
    v_fma_f32 v2, v124, s56, -v242
    v_fma_f32 v3, v125, s56, -v242
    v_fma_f32 v4, v126, s56, -v242
    v_fma_f32 v5, v127, s56, -v242
    v_exp_f32 v2, v2
    v_exp_f32 v3, v3
    v_exp_f32 v4, v4
    v_exp_f32 v5, v5
    s_nop 0
    v_add_f32 v244, v244, v2
    v_add_f32 v245, v245, v3
    v_add_f32 v244, v244, v4
    v_add_f32 v245, v245, v5
    v_cvt_pk_bf16_f32 v110, v2, v3
    v_cvt_pk_bf16_f32 v111, v4, v5
    v_fma_f32 v2, v128, s56, -v242
    v_fma_f32 v3, v129, s56, -v242
    v_fma_f32 v4, v130, s56, -v242
    v_fma_f32 v5, v131, s56, -v242
    v_exp_f32 v2, v2
    v_exp_f32 v3, v3
    v_exp_f32 v4, v4
    v_exp_f32 v5, v5
    s_nop 0
    v_add_f32 v244, v244, v2
    v_add_f32 v245, v245, v3
    v_add_f32 v244, v244, v4
    v_add_f32 v245, v245, v5
    v_cvt_pk_bf16_f32 v112, v2, v3
    v_cvt_pk_bf16_f32 v113, v4, v5
    v_fma_f32 v2, v132, s56, -v242
    v_fma_f32 v3, v133, s56, -v242
    v_fma_f32 v4, v134, s56, -v242
    v_fma_f32 v5, v135, s56, -v242
    v_exp_f32 v2, v2
    v_exp_f32 v3, v3
    v_exp_f32 v4, v4
    v_exp_f32 v5, v5
    s_nop 0
    v_add_f32 v244, v244, v2
    v_add_f32 v245, v245, v3
    v_add_f32 v244, v244, v4
    v_add_f32 v245, v245, v5
    v_cvt_pk_bf16_f32 v114, v2, v3
    v_cvt_pk_bf16_f32 v115, v4, v5
    v_fma_f32 v2, v136, s56, -v242
    v_fma_f32 v3, v137, s56, -v242
    v_fma_f32 v4, v138, s56, -v242
    v_fma_f32 v5, v139, s56, -v242
    v_exp_f32 v2, v2
    v_exp_f32 v3, v3
    v_exp_f32 v4, v4
    v_exp_f32 v5, v5
    s_nop 0
    v_add_f32 v244, v244, v2
    v_add_f32 v245, v245, v3
    v_add_f32 v244, v244, v4
    v_add_f32 v245, v245, v5
    v_cvt_pk_bf16_f32 v116, v2, v3
    v_cvt_pk_bf16_f32 v117, v4, v5
    v_fma_f32 v2, v140, s56, -v242
    v_fma_f32 v3, v141, s56, -v242
    v_fma_f32 v4, v142, s56, -v242
    v_fma_f32 v5, v143, s56, -v242
    v_exp_f32 v2, v2
    v_exp_f32 v3, v3
    v_exp_f32 v4, v4
    v_exp_f32 v5, v5
    s_nop 0
    v_add_f32 v244, v244, v2
    v_add_f32 v245, v245, v3
    v_add_f32 v244, v244, v4
    v_add_f32 v245, v245, v5
    v_cvt_pk_bf16_f32 v118, v2, v3
    v_cvt_pk_bf16_f32 v119, v4, v5
    v_fma_f32 v2, v144, s56, -v242
    v_fma_f32 v3, v145, s56, -v242
    v_fma_f32 v4, v146, s56, -v242
    v_fma_f32 v5, v147, s56, -v242
    v_exp_f32 v2, v2
    v_exp_f32 v3, v3
    v_exp_f32 v4, v4
    v_exp_f32 v5, v5
    s_nop 0
    v_add_f32 v244, v244, v2
    v_add_f32 v245, v245, v3
    v_add_f32 v244, v244, v4
    v_add_f32 v245, v245, v5
    v_cvt_pk_bf16_f32 v120, v2, v3
    v_cvt_pk_bf16_f32 v121, v4, v5
    v_fma_f32 v2, v148, s56, -v242
    v_fma_f32 v3, v149, s56, -v242
    v_fma_f32 v4, v150, s56, -v242
    v_fma_f32 v5, v151, s56, -v242
    v_exp_f32 v2, v2
    v_exp_f32 v3, v3
    v_exp_f32 v4, v4
    v_exp_f32 v5, v5
    s_nop 0
    v_add_f32 v244, v244, v2
    v_add_f32 v245, v245, v3
    v_add_f32 v244, v244, v4
    v_add_f32 v245, v245, v5
    v_cvt_pk_bf16_f32 v122, v2, v3
    v_cvt_pk_bf16_f32 v123, v4, v5
    v_fma_f32 v2, v152, s56, -v242
    v_fma_f32 v3, v153, s56, -v242
    v_fma_f32 v4, v154, s56, -v242
    v_fma_f32 v5, v155, s56, -v242
    v_exp_f32 v2, v2
    v_exp_f32 v3, v3
    v_exp_f32 v4, v4
    v_exp_f32 v5, v5
    s_nop 0
    v_add_f32 v244, v244, v2
    v_add_f32 v245, v245, v3
    v_add_f32 v244, v244, v4
    v_add_f32 v245, v245, v5
    v_cvt_pk_bf16_f32 v124, v2, v3
    v_cvt_pk_bf16_f32 v125, v4, v5
    v_fma_f32 v2, v156, s56, -v242
    v_fma_f32 v3, v157, s56, -v242
    v_fma_f32 v4, v158, s56, -v242
    v_fma_f32 v5, v159, s56, -v242
    v_exp_f32 v2, v2
    v_exp_f32 v3, v3
    v_exp_f32 v4, v4
    v_exp_f32 v5, v5
    s_nop 0
    v_add_f32 v244, v244, v2
    v_add_f32 v245, v245, v3
    v_add_f32 v244, v244, v4
    v_add_f32 v245, v245, v5
    v_cvt_pk_bf16_f32 v126, v2, v3
    v_cvt_pk_bf16_f32 v127, v4, v5
    v_add_f32 v243, v244, v245
    v_mov_b32 v2, v243
    s_nop 1
    v_permlane16_swap_b32 v243, v2
    s_nop 1
    v_add_f32 v243, v243, v2
    v_mov_b32 v2, v243
    s_nop 1
    v_permlane32_swap_b32 v243, v2
    s_nop 1
    v_add_f32 v243, v243, v2
    v_and_b32 v2, 15, v1
    v_lshlrev_b32 v5, 3, v2
    s_lshl_b32 s57, s48, 4
    s_add_u32 s57, s57, 159488
    v_add_u32 v5, s57, v5
    v_lshrrev_b32 v3, 4, v1
    v_lshlrev_b32 v3, 1, v3
    v_and_b32 v4, 1, v1
    v_add_u32 v3, v3, v4
    v_lshlrev_b32 v3, 3, v3
    s_lshl_b32 s57, s48, 8
    v_add_u32 v3, s57, v3
    v_add_u32 v7, 161984, v3
    v_add_u32 v3, 160960, v3
    v_cmp_gt_u32 vcc, 2, v2
    s_mov_b64 s[58:59], vcc
    s_mov_b64 exec, s[58:59]
    ds_write_b64 v3, v[120:121]
    ds_write_b64 v3, v[122:123] offset:64
    ds_write_b64 v3, v[124:125] offset:128
    ds_write_b64 v3, v[126:127] offset:192
    v_mov_b32 v2, 1
    s_mov_b64 exec, 3
    ds_write_b64 v5, v[242:243]
    s_waitcnt lgkmcnt(0)
    s_mov_b64 exec, 1
    ds_add_u32 v9, v2 offset:32
    s_mov_b64 exec, -1
    v_lshlrev_b32 v6, 2, v1
    v_add_u32 v6, s49, v6
    s_waitcnt vmcnt(24)
    ds_read_b64_tr_b16 v[64:65], v20 offset:0
    ds_read_b64_tr_b16 v[66:67], v21 offset:0
    ds_read_b64_tr_b16 v[68:69], v20 offset:256
    ds_read_b64_tr_b16 v[70:71], v21 offset:256
    ds_read_b64_tr_b16 v[72:73], v20 offset:2048
    ds_read_b64_tr_b16 v[74:75], v21 offset:2048
    ds_read_b64_tr_b16 v[76:77], v20 offset:2304
    ds_read_b64_tr_b16 v[78:79], v21 offset:2304
    ds_read_b64_tr_b16 v[80:81], v20 offset:4096
    ds_read_b64_tr_b16 v[82:83], v21 offset:4096
    ds_read_b64_tr_b16 v[84:85], v20 offset:4352
    ds_read_b64_tr_b16 v[86:87], v21 offset:4352
    s_waitcnt lgkmcnt(6)
    ds_read_b64_tr_b16 v[88:89], v20 offset:6144
    ds_read_b64_tr_b16 v[90:91], v21 offset:6144
    ds_read_b64_tr_b16 v[92:93], v20 offset:6400
    ds_read_b64_tr_b16 v[94:95], v21 offset:6400
    s_waitcnt lgkmcnt(0)
    s_add_u32 m0, s49, 0
    s_nop 0
    buffer_load_dwordx4 v28, s[32:35], s53 offen offset:0 nt lds
    buffer_load_dwordx4 v29, s[32:35], s53 offen offset:1024 nt lds
    buffer_load_dwordx4 v30, s[32:35], s53 offen offset:2048 nt lds
    buffer_load_dwordx4 v31, s[32:35], s53 offen offset:3072 nt lds
    s_add_u32 s53, s53, 16384
    s_add_u32 m0, s49, 4096
    s_nop 0
    buffer_load_dwordx4 v28, s[32:35], s53 offen offset:0 nt lds
    buffer_load_dwordx4 v29, s[32:35], s53 offen offset:1024 nt lds
    buffer_load_dwordx4 v30, s[32:35], s53 offen offset:2048 nt lds
    buffer_load_dwordx4 v31, s[32:35], s53 offen offset:3072 nt lds
    s_add_u32 s53, s53, 16384
    v_mfma_f32_4x4x4_16b_bf16 v[160:163], v[96:97], v[64:65], 0 cbsz:4 abid:0
    v_mfma_f32_4x4x4_16b_bf16 v[164:167], v[96:97], v[66:67], 0 cbsz:4 abid:0
    v_mfma_f32_4x4x4_16b_bf16 v[168:171], v[96:97], v[68:69], 0 cbsz:4 abid:0
    v_mfma_f32_4x4x4_16b_bf16 v[172:175], v[96:97], v[70:71], 0 cbsz:4 abid:0
    v_mfma_f32_4x4x4_16b_bf16 v[160:163], v[96:97], v[72:73], v[160:163] cbsz:4 abid:4
    v_mfma_f32_4x4x4_16b_bf16 v[164:167], v[96:97], v[74:75], v[164:167] cbsz:4 abid:4
    v_mfma_f32_4x4x4_16b_bf16 v[168:171], v[96:97], v[76:77], v[168:171] cbsz:4 abid:4
    v_mfma_f32_4x4x4_16b_bf16 v[172:175], v[96:97], v[78:79], v[172:175] cbsz:4 abid:4
    v_mfma_f32_4x4x4_16b_bf16 v[160:163], v[96:97], v[80:81], v[160:163] cbsz:4 abid:8
    v_mfma_f32_4x4x4_16b_bf16 v[164:167], v[96:97], v[82:83], v[164:167] cbsz:4 abid:8
    v_mfma_f32_4x4x4_16b_bf16 v[168:171], v[96:97], v[84:85], v[168:171] cbsz:4 abid:8
    v_mfma_f32_4x4x4_16b_bf16 v[172:175], v[96:97], v[86:87], v[172:175] cbsz:4 abid:8
    v_mfma_f32_4x4x4_16b_bf16 v[160:163], v[96:97], v[88:89], v[160:163] cbsz:4 abid:12
    v_mfma_f32_4x4x4_16b_bf16 v[164:167], v[96:97], v[90:91], v[164:167] cbsz:4 abid:12
    v_mfma_f32_4x4x4_16b_bf16 v[168:171], v[96:97], v[92:93], v[168:171] cbsz:4 abid:12
    v_mfma_f32_4x4x4_16b_bf16 v[172:175], v[96:97], v[94:95], v[172:175] cbsz:4 abid:12
    s_mov_b64 exec, 1
    v_mov_b32 v2, 1
    ds_add_u32 v9, v2 offset:40
    s_mov_b64 exec, -1
    s_waitcnt vmcnt(24)
    ds_read_b64_tr_b16 v[64:65], v20 offset:8192
    ds_read_b64_tr_b16 v[66:67], v21 offset:8192
    ds_read_b64_tr_b16 v[68:69], v20 offset:8448
    ds_read_b64_tr_b16 v[70:71], v21 offset:8448
    ds_read_b64_tr_b16 v[72:73], v20 offset:10240
    ds_read_b64_tr_b16 v[74:75], v21 offset:10240
    ds_read_b64_tr_b16 v[76:77], v20 offset:10496
    ds_read_b64_tr_b16 v[78:79], v21 offset:10496
    ds_read_b64_tr_b16 v[80:81], v20 offset:12288
    ds_read_b64_tr_b16 v[82:83], v21 offset:12288
    ds_read_b64_tr_b16 v[84:85], v20 offset:12544
    ds_read_b64_tr_b16 v[86:87], v21 offset:12544
    s_waitcnt lgkmcnt(6)
    ds_read_b64_tr_b16 v[88:89], v20 offset:14336
    ds_read_b64_tr_b16 v[90:91], v21 offset:14336
    ds_read_b64_tr_b16 v[92:93], v20 offset:14592
    ds_read_b64_tr_b16 v[94:95], v21 offset:14592
    s_waitcnt lgkmcnt(0)
    s_add_u32 m0, s49, 8192
    s_nop 0
    buffer_load_dwordx4 v28, s[32:35], s53 offen offset:0 nt lds
    buffer_load_dwordx4 v29, s[32:35], s53 offen offset:1024 nt lds
    buffer_load_dwordx4 v30, s[32:35], s53 offen offset:2048 nt lds
    buffer_load_dwordx4 v31, s[32:35], s53 offen offset:3072 nt lds
    s_add_u32 s53, s53, 16384
    s_add_u32 m0, s49, 12288
    s_nop 0
    buffer_load_dwordx4 v28, s[32:35], s53 offen offset:0 nt lds
    buffer_load_dwordx4 v29, s[32:35], s53 offen offset:1024 nt lds
    buffer_load_dwordx4 v30, s[32:35], s53 offen offset:2048 nt lds
    buffer_load_dwordx4 v31, s[32:35], s53 offen offset:3072 nt lds
    s_add_u32 s53, s53, 16384
    v_mfma_f32_4x4x4_16b_bf16 v[160:163], v[98:99], v[64:65], v[160:163] cbsz:4 abid:0
    v_mfma_f32_4x4x4_16b_bf16 v[164:167], v[98:99], v[66:67], v[164:167] cbsz:4 abid:0
    v_mfma_f32_4x4x4_16b_bf16 v[168:171], v[98:99], v[68:69], v[168:171] cbsz:4 abid:0
    v_mfma_f32_4x4x4_16b_bf16 v[172:175], v[98:99], v[70:71], v[172:175] cbsz:4 abid:0
    v_mfma_f32_4x4x4_16b_bf16 v[160:163], v[98:99], v[72:73], v[160:163] cbsz:4 abid:4
    v_mfma_f32_4x4x4_16b_bf16 v[164:167], v[98:99], v[74:75], v[164:167] cbsz:4 abid:4
    v_mfma_f32_4x4x4_16b_bf16 v[168:171], v[98:99], v[76:77], v[168:171] cbsz:4 abid:4
    v_mfma_f32_4x4x4_16b_bf16 v[172:175], v[98:99], v[78:79], v[172:175] cbsz:4 abid:4
    v_mfma_f32_4x4x4_16b_bf16 v[160:163], v[98:99], v[80:81], v[160:163] cbsz:4 abid:8
    v_mfma_f32_4x4x4_16b_bf16 v[164:167], v[98:99], v[82:83], v[164:167] cbsz:4 abid:8
    v_mfma_f32_4x4x4_16b_bf16 v[168:171], v[98:99], v[84:85], v[168:171] cbsz:4 abid:8
    v_mfma_f32_4x4x4_16b_bf16 v[172:175], v[98:99], v[86:87], v[172:175] cbsz:4 abid:8
    v_mfma_f32_4x4x4_16b_bf16 v[160:163], v[98:99], v[88:89], v[160:163] cbsz:4 abid:12
    v_mfma_f32_4x4x4_16b_bf16 v[164:167], v[98:99], v[90:91], v[164:167] cbsz:4 abid:12
    v_mfma_f32_4x4x4_16b_bf16 v[168:171], v[98:99], v[92:93], v[168:171] cbsz:4 abid:12
    v_mfma_f32_4x4x4_16b_bf16 v[172:175], v[98:99], v[94:95], v[172:175] cbsz:4 abid:12
    s_waitcnt vmcnt(24)
    ds_read_b64_tr_b16 v[64:65], v20 offset:16384
    ds_read_b64_tr_b16 v[66:67], v21 offset:16384
    ds_read_b64_tr_b16 v[68:69], v20 offset:16640
    ds_read_b64_tr_b16 v[70:71], v21 offset:16640
    ds_read_b64_tr_b16 v[72:73], v20 offset:18432
    ds_read_b64_tr_b16 v[74:75], v21 offset:18432
    ds_read_b64_tr_b16 v[76:77], v20 offset:18688
    ds_read_b64_tr_b16 v[78:79], v21 offset:18688
    ds_read_b64_tr_b16 v[80:81], v20 offset:20480
    ds_read_b64_tr_b16 v[82:83], v21 offset:20480
    ds_read_b64_tr_b16 v[84:85], v20 offset:20736
    ds_read_b64_tr_b16 v[86:87], v21 offset:20736
    s_waitcnt lgkmcnt(6)
    ds_read_b64_tr_b16 v[88:89], v20 offset:22528
    ds_read_b64_tr_b16 v[90:91], v21 offset:22528
    ds_read_b64_tr_b16 v[92:93], v20 offset:22784
    ds_read_b64_tr_b16 v[94:95], v21 offset:22784
    s_waitcnt lgkmcnt(0)
    s_add_u32 m0, s49, 16384
    s_nop 0
    buffer_load_dwordx4 v28, s[32:35], s53 offen offset:0 nt lds
    buffer_load_dwordx4 v29, s[32:35], s53 offen offset:1024 nt lds
    buffer_load_dwordx4 v30, s[32:35], s53 offen offset:2048 nt lds
    buffer_load_dwordx4 v31, s[32:35], s53 offen offset:3072 nt lds
    s_add_u32 s53, s53, 16384
    s_add_u32 m0, s49, 20480
    s_nop 0
    buffer_load_dwordx4 v28, s[32:35], s53 offen offset:0 nt lds
    buffer_load_dwordx4 v29, s[32:35], s53 offen offset:1024 nt lds
    buffer_load_dwordx4 v30, s[32:35], s53 offen offset:2048 nt lds
    buffer_load_dwordx4 v31, s[32:35], s53 offen offset:3072 nt lds
    s_add_u32 s53, s53, 16384
    v_mfma_f32_4x4x4_16b_bf16 v[160:163], v[100:101], v[64:65], v[160:163] cbsz:4 abid:0
    v_mfma_f32_4x4x4_16b_bf16 v[164:167], v[100:101], v[66:67], v[164:167] cbsz:4 abid:0
    v_mfma_f32_4x4x4_16b_bf16 v[168:171], v[100:101], v[68:69], v[168:171] cbsz:4 abid:0
    v_mfma_f32_4x4x4_16b_bf16 v[172:175], v[100:101], v[70:71], v[172:175] cbsz:4 abid:0
    v_mfma_f32_4x4x4_16b_bf16 v[160:163], v[100:101], v[72:73], v[160:163] cbsz:4 abid:4
    v_mfma_f32_4x4x4_16b_bf16 v[164:167], v[100:101], v[74:75], v[164:167] cbsz:4 abid:4
    v_mfma_f32_4x4x4_16b_bf16 v[168:171], v[100:101], v[76:77], v[168:171] cbsz:4 abid:4
    v_mfma_f32_4x4x4_16b_bf16 v[172:175], v[100:101], v[78:79], v[172:175] cbsz:4 abid:4
    v_mfma_f32_4x4x4_16b_bf16 v[160:163], v[100:101], v[80:81], v[160:163] cbsz:4 abid:8
    v_mfma_f32_4x4x4_16b_bf16 v[164:167], v[100:101], v[82:83], v[164:167] cbsz:4 abid:8
    v_mfma_f32_4x4x4_16b_bf16 v[168:171], v[100:101], v[84:85], v[168:171] cbsz:4 abid:8
    v_mfma_f32_4x4x4_16b_bf16 v[172:175], v[100:101], v[86:87], v[172:175] cbsz:4 abid:8
    v_mfma_f32_4x4x4_16b_bf16 v[160:163], v[100:101], v[88:89], v[160:163] cbsz:4 abid:12
    v_mfma_f32_4x4x4_16b_bf16 v[164:167], v[100:101], v[90:91], v[164:167] cbsz:4 abid:12
    v_mfma_f32_4x4x4_16b_bf16 v[168:171], v[100:101], v[92:93], v[168:171] cbsz:4 abid:12
    v_mfma_f32_4x4x4_16b_bf16 v[172:175], v[100:101], v[94:95], v[172:175] cbsz:4 abid:12
    s_waitcnt vmcnt(24)
    ds_read_b64_tr_b16 v[64:65], v20 offset:24576
    ds_read_b64_tr_b16 v[66:67], v21 offset:24576
    ds_read_b64_tr_b16 v[68:69], v20 offset:24832
    ds_read_b64_tr_b16 v[70:71], v21 offset:24832
    ds_read_b64_tr_b16 v[72:73], v20 offset:26624
    ds_read_b64_tr_b16 v[74:75], v21 offset:26624
    ds_read_b64_tr_b16 v[76:77], v20 offset:26880
    ds_read_b64_tr_b16 v[78:79], v21 offset:26880
    ds_read_b64_tr_b16 v[80:81], v20 offset:28672
    ds_read_b64_tr_b16 v[82:83], v21 offset:28672
    ds_read_b64_tr_b16 v[84:85], v20 offset:28928
    ds_read_b64_tr_b16 v[86:87], v21 offset:28928
    s_waitcnt lgkmcnt(6)
    ds_read_b64_tr_b16 v[88:89], v20 offset:30720
    ds_read_b64_tr_b16 v[90:91], v21 offset:30720
    ds_read_b64_tr_b16 v[92:93], v20 offset:30976
    ds_read_b64_tr_b16 v[94:95], v21 offset:30976
    s_waitcnt lgkmcnt(0)
    s_add_u32 m0, s49, 24576
    s_nop 0
    buffer_load_dwordx4 v28, s[32:35], s53 offen offset:0 nt lds
    buffer_load_dwordx4 v29, s[32:35], s53 offen offset:1024 nt lds
    buffer_load_dwordx4 v30, s[32:35], s53 offen offset:2048 nt lds
    buffer_load_dwordx4 v31, s[32:35], s53 offen offset:3072 nt lds
    s_add_u32 s53, s53, 16384
    s_add_u32 m0, s49, 28672
    s_nop 0
    buffer_load_dwordx4 v28, s[32:35], s53 offen offset:0 nt lds
    buffer_load_dwordx4 v29, s[32:35], s53 offen offset:1024 nt lds
    buffer_load_dwordx4 v30, s[32:35], s53 offen offset:2048 nt lds
    buffer_load_dwordx4 v31, s[32:35], s53 offen offset:3072 nt lds
    s_add_u32 s53, s53, 16384
    v_mfma_f32_4x4x4_16b_bf16 v[160:163], v[102:103], v[64:65], v[160:163] cbsz:4 abid:0
    v_mfma_f32_4x4x4_16b_bf16 v[164:167], v[102:103], v[66:67], v[164:167] cbsz:4 abid:0
    v_mfma_f32_4x4x4_16b_bf16 v[168:171], v[102:103], v[68:69], v[168:171] cbsz:4 abid:0
    v_mfma_f32_4x4x4_16b_bf16 v[172:175], v[102:103], v[70:71], v[172:175] cbsz:4 abid:0
    v_mfma_f32_4x4x4_16b_bf16 v[160:163], v[102:103], v[72:73], v[160:163] cbsz:4 abid:4
    v_mfma_f32_4x4x4_16b_bf16 v[164:167], v[102:103], v[74:75], v[164:167] cbsz:4 abid:4
    v_mfma_f32_4x4x4_16b_bf16 v[168:171], v[102:103], v[76:77], v[168:171] cbsz:4 abid:4
    v_mfma_f32_4x4x4_16b_bf16 v[172:175], v[102:103], v[78:79], v[172:175] cbsz:4 abid:4
    v_mfma_f32_4x4x4_16b_bf16 v[160:163], v[102:103], v[80:81], v[160:163] cbsz:4 abid:8
    v_mfma_f32_4x4x4_16b_bf16 v[164:167], v[102:103], v[82:83], v[164:167] cbsz:4 abid:8
    v_mfma_f32_4x4x4_16b_bf16 v[168:171], v[102:103], v[84:85], v[168:171] cbsz:4 abid:8
    v_mfma_f32_4x4x4_16b_bf16 v[172:175], v[102:103], v[86:87], v[172:175] cbsz:4 abid:8
    v_mfma_f32_4x4x4_16b_bf16 v[160:163], v[102:103], v[88:89], v[160:163] cbsz:4 abid:12
    v_mfma_f32_4x4x4_16b_bf16 v[164:167], v[102:103], v[90:91], v[164:167] cbsz:4 abid:12
    v_mfma_f32_4x4x4_16b_bf16 v[168:171], v[102:103], v[92:93], v[168:171] cbsz:4 abid:12
    v_mfma_f32_4x4x4_16b_bf16 v[172:175], v[102:103], v[94:95], v[172:175] cbsz:4 abid:12
    s_waitcnt vmcnt(24)
    ds_read_b64_tr_b16 v[64:65], v20 offset:0
    ds_read_b64_tr_b16 v[66:67], v21 offset:0
    ds_read_b64_tr_b16 v[68:69], v20 offset:256
    ds_read_b64_tr_b16 v[70:71], v21 offset:256
    ds_read_b64_tr_b16 v[72:73], v20 offset:2048
    ds_read_b64_tr_b16 v[74:75], v21 offset:2048
    ds_read_b64_tr_b16 v[76:77], v20 offset:2304
    ds_read_b64_tr_b16 v[78:79], v21 offset:2304
    ds_read_b64_tr_b16 v[80:81], v20 offset:4096
    ds_read_b64_tr_b16 v[82:83], v21 offset:4096
    ds_read_b64_tr_b16 v[84:85], v20 offset:4352
    ds_read_b64_tr_b16 v[86:87], v21 offset:4352
    s_waitcnt lgkmcnt(6)
    ds_read_b64_tr_b16 v[88:89], v20 offset:6144
    ds_read_b64_tr_b16 v[90:91], v21 offset:6144
    ds_read_b64_tr_b16 v[92:93], v20 offset:6400
    ds_read_b64_tr_b16 v[94:95], v21 offset:6400
    s_waitcnt lgkmcnt(0)
    s_add_u32 m0, s49, 0
    s_nop 0
    buffer_load_dwordx4 v28, s[32:35], s53 offen offset:0 nt lds
    buffer_load_dwordx4 v29, s[32:35], s53 offen offset:1024 nt lds
    buffer_load_dwordx4 v30, s[32:35], s53 offen offset:2048 nt lds
    buffer_load_dwordx4 v31, s[32:35], s53 offen offset:3072 nt lds
    s_add_u32 s53, s53, 16384
    s_add_u32 m0, s49, 4096
    s_nop 0
    buffer_load_dwordx4 v28, s[32:35], s53 offen offset:0 nt lds
    buffer_load_dwordx4 v29, s[32:35], s53 offen offset:1024 nt lds
    buffer_load_dwordx4 v30, s[32:35], s53 offen offset:2048 nt lds
    buffer_load_dwordx4 v31, s[32:35], s53 offen offset:3072 nt lds
    s_add_u32 s53, s53, 16384
    v_mfma_f32_4x4x4_16b_bf16 v[160:163], v[104:105], v[64:65], v[160:163] cbsz:4 abid:0
    v_mfma_f32_4x4x4_16b_bf16 v[164:167], v[104:105], v[66:67], v[164:167] cbsz:4 abid:0
    v_mfma_f32_4x4x4_16b_bf16 v[168:171], v[104:105], v[68:69], v[168:171] cbsz:4 abid:0
    v_mfma_f32_4x4x4_16b_bf16 v[172:175], v[104:105], v[70:71], v[172:175] cbsz:4 abid:0
    v_mfma_f32_4x4x4_16b_bf16 v[160:163], v[104:105], v[72:73], v[160:163] cbsz:4 abid:4
    v_mfma_f32_4x4x4_16b_bf16 v[164:167], v[104:105], v[74:75], v[164:167] cbsz:4 abid:4
    v_mfma_f32_4x4x4_16b_bf16 v[168:171], v[104:105], v[76:77], v[168:171] cbsz:4 abid:4
    v_mfma_f32_4x4x4_16b_bf16 v[172:175], v[104:105], v[78:79], v[172:175] cbsz:4 abid:4
    v_mfma_f32_4x4x4_16b_bf16 v[160:163], v[104:105], v[80:81], v[160:163] cbsz:4 abid:8
    v_mfma_f32_4x4x4_16b_bf16 v[164:167], v[104:105], v[82:83], v[164:167] cbsz:4 abid:8
    v_mfma_f32_4x4x4_16b_bf16 v[168:171], v[104:105], v[84:85], v[168:171] cbsz:4 abid:8
    v_mfma_f32_4x4x4_16b_bf16 v[172:175], v[104:105], v[86:87], v[172:175] cbsz:4 abid:8
    v_mfma_f32_4x4x4_16b_bf16 v[160:163], v[104:105], v[88:89], v[160:163] cbsz:4 abid:12
    v_mfma_f32_4x4x4_16b_bf16 v[164:167], v[104:105], v[90:91], v[164:167] cbsz:4 abid:12
    v_mfma_f32_4x4x4_16b_bf16 v[168:171], v[104:105], v[92:93], v[168:171] cbsz:4 abid:12
    v_mfma_f32_4x4x4_16b_bf16 v[172:175], v[104:105], v[94:95], v[172:175] cbsz:4 abid:12
    s_waitcnt vmcnt(24)
    ds_read_b64_tr_b16 v[64:65], v20 offset:8192
    ds_read_b64_tr_b16 v[66:67], v21 offset:8192
    ds_read_b64_tr_b16 v[68:69], v20 offset:8448
    ds_read_b64_tr_b16 v[70:71], v21 offset:8448
    ds_read_b64_tr_b16 v[72:73], v20 offset:10240
    ds_read_b64_tr_b16 v[74:75], v21 offset:10240
    ds_read_b64_tr_b16 v[76:77], v20 offset:10496
    ds_read_b64_tr_b16 v[78:79], v21 offset:10496
    ds_read_b64_tr_b16 v[80:81], v20 offset:12288
    ds_read_b64_tr_b16 v[82:83], v21 offset:12288
    ds_read_b64_tr_b16 v[84:85], v20 offset:12544
    ds_read_b64_tr_b16 v[86:87], v21 offset:12544
    s_waitcnt lgkmcnt(6)
    ds_read_b64_tr_b16 v[88:89], v20 offset:14336
    ds_read_b64_tr_b16 v[90:91], v21 offset:14336
    ds_read_b64_tr_b16 v[92:93], v20 offset:14592
    ds_read_b64_tr_b16 v[94:95], v21 offset:14592
    s_waitcnt lgkmcnt(0)
    s_add_u32 m0, s49, 8192
    s_nop 0
    buffer_load_dwordx4 v28, s[32:35], s53 offen offset:0 nt lds
    buffer_load_dwordx4 v29, s[32:35], s53 offen offset:1024 nt lds
    buffer_load_dwordx4 v30, s[32:35], s53 offen offset:2048 nt lds
    buffer_load_dwordx4 v31, s[32:35], s53 offen offset:3072 nt lds
    s_add_u32 s53, s53, 16384
    s_add_u32 m0, s49, 12288
    s_nop 0
    buffer_load_dwordx4 v28, s[32:35], s53 offen offset:0 nt lds
    buffer_load_dwordx4 v29, s[32:35], s53 offen offset:1024 nt lds
    buffer_load_dwordx4 v30, s[32:35], s53 offen offset:2048 nt lds
    buffer_load_dwordx4 v31, s[32:35], s53 offen offset:3072 nt lds
    s_add_u32 s53, s53, 16384
    v_mfma_f32_4x4x4_16b_bf16 v[160:163], v[106:107], v[64:65], v[160:163] cbsz:4 abid:0
    v_mfma_f32_4x4x4_16b_bf16 v[164:167], v[106:107], v[66:67], v[164:167] cbsz:4 abid:0
    v_mfma_f32_4x4x4_16b_bf16 v[168:171], v[106:107], v[68:69], v[168:171] cbsz:4 abid:0
    v_mfma_f32_4x4x4_16b_bf16 v[172:175], v[106:107], v[70:71], v[172:175] cbsz:4 abid:0
    v_mfma_f32_4x4x4_16b_bf16 v[160:163], v[106:107], v[72:73], v[160:163] cbsz:4 abid:4
    v_mfma_f32_4x4x4_16b_bf16 v[164:167], v[106:107], v[74:75], v[164:167] cbsz:4 abid:4
    v_mfma_f32_4x4x4_16b_bf16 v[168:171], v[106:107], v[76:77], v[168:171] cbsz:4 abid:4
    v_mfma_f32_4x4x4_16b_bf16 v[172:175], v[106:107], v[78:79], v[172:175] cbsz:4 abid:4
    v_mfma_f32_4x4x4_16b_bf16 v[160:163], v[106:107], v[80:81], v[160:163] cbsz:4 abid:8
    v_mfma_f32_4x4x4_16b_bf16 v[164:167], v[106:107], v[82:83], v[164:167] cbsz:4 abid:8
    v_mfma_f32_4x4x4_16b_bf16 v[168:171], v[106:107], v[84:85], v[168:171] cbsz:4 abid:8
    v_mfma_f32_4x4x4_16b_bf16 v[172:175], v[106:107], v[86:87], v[172:175] cbsz:4 abid:8
    v_mfma_f32_4x4x4_16b_bf16 v[160:163], v[106:107], v[88:89], v[160:163] cbsz:4 abid:12
    v_mfma_f32_4x4x4_16b_bf16 v[164:167], v[106:107], v[90:91], v[164:167] cbsz:4 abid:12
    v_mfma_f32_4x4x4_16b_bf16 v[168:171], v[106:107], v[92:93], v[168:171] cbsz:4 abid:12
    v_mfma_f32_4x4x4_16b_bf16 v[172:175], v[106:107], v[94:95], v[172:175] cbsz:4 abid:12
    s_waitcnt vmcnt(24)
    ds_read_b64_tr_b16 v[64:65], v20 offset:16384
    ds_read_b64_tr_b16 v[66:67], v21 offset:16384
    ds_read_b64_tr_b16 v[68:69], v20 offset:16640
    ds_read_b64_tr_b16 v[70:71], v21 offset:16640
    ds_read_b64_tr_b16 v[72:73], v20 offset:18432
    ds_read_b64_tr_b16 v[74:75], v21 offset:18432
    ds_read_b64_tr_b16 v[76:77], v20 offset:18688
    ds_read_b64_tr_b16 v[78:79], v21 offset:18688
    ds_read_b64_tr_b16 v[80:81], v20 offset:20480
    ds_read_b64_tr_b16 v[82:83], v21 offset:20480
    ds_read_b64_tr_b16 v[84:85], v20 offset:20736
    ds_read_b64_tr_b16 v[86:87], v21 offset:20736
    s_waitcnt lgkmcnt(6)
    ds_read_b64_tr_b16 v[88:89], v20 offset:22528
    ds_read_b64_tr_b16 v[90:91], v21 offset:22528
    ds_read_b64_tr_b16 v[92:93], v20 offset:22784
    ds_read_b64_tr_b16 v[94:95], v21 offset:22784
    s_waitcnt lgkmcnt(0)
    s_add_u32 m0, s49, 16384
    s_nop 0
    buffer_load_dwordx4 v28, s[32:35], s53 offen offset:0 nt lds
    buffer_load_dwordx4 v29, s[32:35], s53 offen offset:1024 nt lds
    buffer_load_dwordx4 v30, s[32:35], s53 offen offset:2048 nt lds
    buffer_load_dwordx4 v31, s[32:35], s53 offen offset:3072 nt lds
    s_add_u32 s53, s53, 16384
    s_add_u32 m0, s49, 20480
    s_nop 0
    buffer_load_dwordx4 v28, s[32:35], s53 offen offset:0 nt lds
    buffer_load_dwordx4 v29, s[32:35], s53 offen offset:1024 nt lds
    buffer_load_dwordx4 v30, s[32:35], s53 offen offset:2048 nt lds
    buffer_load_dwordx4 v31, s[32:35], s53 offen offset:3072 nt lds
    s_add_u32 s53, s53, 16384
    v_mfma_f32_4x4x4_16b_bf16 v[160:163], v[108:109], v[64:65], v[160:163] cbsz:4 abid:0
    v_mfma_f32_4x4x4_16b_bf16 v[164:167], v[108:109], v[66:67], v[164:167] cbsz:4 abid:0
    v_mfma_f32_4x4x4_16b_bf16 v[168:171], v[108:109], v[68:69], v[168:171] cbsz:4 abid:0
    v_mfma_f32_4x4x4_16b_bf16 v[172:175], v[108:109], v[70:71], v[172:175] cbsz:4 abid:0
    v_mfma_f32_4x4x4_16b_bf16 v[160:163], v[108:109], v[72:73], v[160:163] cbsz:4 abid:4
    v_mfma_f32_4x4x4_16b_bf16 v[164:167], v[108:109], v[74:75], v[164:167] cbsz:4 abid:4
    v_mfma_f32_4x4x4_16b_bf16 v[168:171], v[108:109], v[76:77], v[168:171] cbsz:4 abid:4
    v_mfma_f32_4x4x4_16b_bf16 v[172:175], v[108:109], v[78:79], v[172:175] cbsz:4 abid:4
    v_mfma_f32_4x4x4_16b_bf16 v[160:163], v[108:109], v[80:81], v[160:163] cbsz:4 abid:8
    v_mfma_f32_4x4x4_16b_bf16 v[164:167], v[108:109], v[82:83], v[164:167] cbsz:4 abid:8
    v_mfma_f32_4x4x4_16b_bf16 v[168:171], v[108:109], v[84:85], v[168:171] cbsz:4 abid:8
    v_mfma_f32_4x4x4_16b_bf16 v[172:175], v[108:109], v[86:87], v[172:175] cbsz:4 abid:8
    v_mfma_f32_4x4x4_16b_bf16 v[160:163], v[108:109], v[88:89], v[160:163] cbsz:4 abid:12
    v_mfma_f32_4x4x4_16b_bf16 v[164:167], v[108:109], v[90:91], v[164:167] cbsz:4 abid:12
    v_mfma_f32_4x4x4_16b_bf16 v[168:171], v[108:109], v[92:93], v[168:171] cbsz:4 abid:12
    v_mfma_f32_4x4x4_16b_bf16 v[172:175], v[108:109], v[94:95], v[172:175] cbsz:4 abid:12
    s_waitcnt vmcnt(24)
    ds_read_b64_tr_b16 v[64:65], v20 offset:24576
    ds_read_b64_tr_b16 v[66:67], v21 offset:24576
    ds_read_b64_tr_b16 v[68:69], v20 offset:24832
    ds_read_b64_tr_b16 v[70:71], v21 offset:24832
    ds_read_b64_tr_b16 v[72:73], v20 offset:26624
    ds_read_b64_tr_b16 v[74:75], v21 offset:26624
    ds_read_b64_tr_b16 v[76:77], v20 offset:26880
    ds_read_b64_tr_b16 v[78:79], v21 offset:26880
    ds_read_b64_tr_b16 v[80:81], v20 offset:28672
    ds_read_b64_tr_b16 v[82:83], v21 offset:28672
    ds_read_b64_tr_b16 v[84:85], v20 offset:28928
    ds_read_b64_tr_b16 v[86:87], v21 offset:28928
    s_waitcnt lgkmcnt(6)
    ds_read_b64_tr_b16 v[88:89], v20 offset:30720
    ds_read_b64_tr_b16 v[90:91], v21 offset:30720
    ds_read_b64_tr_b16 v[92:93], v20 offset:30976
    ds_read_b64_tr_b16 v[94:95], v21 offset:30976
    s_waitcnt lgkmcnt(0)
    s_add_u32 m0, s49, 24576
    s_nop 0
    buffer_load_dwordx4 v28, s[32:35], s53 offen offset:0 nt lds
    buffer_load_dwordx4 v29, s[32:35], s53 offen offset:1024 nt lds
    buffer_load_dwordx4 v30, s[32:35], s53 offen offset:2048 nt lds
    buffer_load_dwordx4 v31, s[32:35], s53 offen offset:3072 nt lds
    s_add_u32 s53, s53, 16384
    s_add_u32 m0, s49, 28672
    s_nop 0
    buffer_load_dwordx4 v28, s[32:35], s53 offen offset:0 nt lds
    buffer_load_dwordx4 v29, s[32:35], s53 offen offset:1024 nt lds
    buffer_load_dwordx4 v30, s[32:35], s53 offen offset:2048 nt lds
    buffer_load_dwordx4 v31, s[32:35], s53 offen offset:3072 nt lds
    s_add_u32 s53, s53, 16384
    v_mfma_f32_4x4x4_16b_bf16 v[160:163], v[110:111], v[64:65], v[160:163] cbsz:4 abid:0
    v_mfma_f32_4x4x4_16b_bf16 v[164:167], v[110:111], v[66:67], v[164:167] cbsz:4 abid:0
    v_mfma_f32_4x4x4_16b_bf16 v[168:171], v[110:111], v[68:69], v[168:171] cbsz:4 abid:0
    v_mfma_f32_4x4x4_16b_bf16 v[172:175], v[110:111], v[70:71], v[172:175] cbsz:4 abid:0
    v_mfma_f32_4x4x4_16b_bf16 v[160:163], v[110:111], v[72:73], v[160:163] cbsz:4 abid:4
    v_mfma_f32_4x4x4_16b_bf16 v[164:167], v[110:111], v[74:75], v[164:167] cbsz:4 abid:4
    v_mfma_f32_4x4x4_16b_bf16 v[168:171], v[110:111], v[76:77], v[168:171] cbsz:4 abid:4
    v_mfma_f32_4x4x4_16b_bf16 v[172:175], v[110:111], v[78:79], v[172:175] cbsz:4 abid:4
    v_mfma_f32_4x4x4_16b_bf16 v[160:163], v[110:111], v[80:81], v[160:163] cbsz:4 abid:8
    v_mfma_f32_4x4x4_16b_bf16 v[164:167], v[110:111], v[82:83], v[164:167] cbsz:4 abid:8
    v_mfma_f32_4x4x4_16b_bf16 v[168:171], v[110:111], v[84:85], v[168:171] cbsz:4 abid:8
    v_mfma_f32_4x4x4_16b_bf16 v[172:175], v[110:111], v[86:87], v[172:175] cbsz:4 abid:8
    v_mfma_f32_4x4x4_16b_bf16 v[160:163], v[110:111], v[88:89], v[160:163] cbsz:4 abid:12
    v_mfma_f32_4x4x4_16b_bf16 v[164:167], v[110:111], v[90:91], v[164:167] cbsz:4 abid:12
    v_mfma_f32_4x4x4_16b_bf16 v[168:171], v[110:111], v[92:93], v[168:171] cbsz:4 abid:12
    v_mfma_f32_4x4x4_16b_bf16 v[172:175], v[110:111], v[94:95], v[172:175] cbsz:4 abid:12
    s_waitcnt vmcnt(24)
    ds_read_b64_tr_b16 v[64:65], v20 offset:0
    ds_read_b64_tr_b16 v[66:67], v21 offset:0
    ds_read_b64_tr_b16 v[68:69], v20 offset:256
    ds_read_b64_tr_b16 v[70:71], v21 offset:256
    ds_read_b64_tr_b16 v[72:73], v20 offset:2048
    ds_read_b64_tr_b16 v[74:75], v21 offset:2048
    ds_read_b64_tr_b16 v[76:77], v20 offset:2304
    ds_read_b64_tr_b16 v[78:79], v21 offset:2304
    ds_read_b64_tr_b16 v[80:81], v20 offset:4096
    ds_read_b64_tr_b16 v[82:83], v21 offset:4096
    ds_read_b64_tr_b16 v[84:85], v20 offset:4352
    ds_read_b64_tr_b16 v[86:87], v21 offset:4352
    s_waitcnt lgkmcnt(6)
    ds_read_b64_tr_b16 v[88:89], v20 offset:6144
    ds_read_b64_tr_b16 v[90:91], v21 offset:6144
    ds_read_b64_tr_b16 v[92:93], v20 offset:6400
    ds_read_b64_tr_b16 v[94:95], v21 offset:6400
    s_waitcnt lgkmcnt(0)
    s_mov_b32 s96, 800000
L_lw_3:
    ds_read_b32 v2, v9 offset:28
    s_waitcnt lgkmcnt(0)
    v_readfirstlane_b32 s56, v2
    s_sub_u32 s96, s96, 1
    s_cbranch_scc1 L_lwd_4
    s_cmp_ge_u32 s56, 1
    s_cbranch_scc0 L_lw_3
L_lwd_4:
    s_bfe_u32 s58, s56, 0x10001
    s_lshr_b32 s57, s56, 2
    s_add_u32 s57, s57, 3
    s_sub_u32 s57, s57, s48
    s_lshr_b32 s57, s57, 2
    s_cmp_gt_u32 s57, 0
    s_cselect_b32 s74, 1, 0
    s_andn2_b32 s70, s74, s58
    s_and_b32 s74, s74, s58
    s_xor_b32 s67, s74, 1
    s_cmp_gt_u32 s57, 1
    s_cselect_b32 s74, 1, 0
    s_andn2_b32 s71, s74, s58
    s_and_b32 s74, s74, s58
    s_xor_b32 s66, s74, 1
    s_cmp_gt_u32 s57, 2
    s_cselect_b32 s74, 1, 0
    s_andn2_b32 s72, s74, s58
    s_and_b32 s74, s74, s58
    s_xor_b32 s65, s74, 1
    s_cmp_gt_u32 s57, 3
    s_cselect_b32 s74, 1, 0
    s_andn2_b32 s73, s74, s58
    s_and_b32 s74, s74, s58
    s_xor_b32 s64, s74, 1
    v_and_b32 v2, 15, v1
    v_cmp_gt_u32 vcc, 2, v2
    s_mov_b64 s[58:59], vcc
    s_cmp_eq_u32 s64, 0
    s_cbranch_scc1 L_ig_5
    s_add_u32 m0, s49, 0
    s_nop 0
    buffer_load_dwordx4 v28, s[32:35], s53 offen offset:0 nt lds
    buffer_load_dwordx4 v29, s[32:35], s53 offen offset:1024 nt lds
    buffer_load_dwordx4 v30, s[32:35], s53 offen offset:2048 nt lds
    buffer_load_dwordx4 v31, s[32:35], s53 offen offset:3072 nt lds
    s_add_u32 s53, s53, 16384
    s_add_u32 m0, s49, 4096
    s_nop 0
    buffer_load_dwordx4 v28, s[32:35], s53 offen offset:0 nt lds
    buffer_load_dwordx4 v29, s[32:35], s53 offen offset:1024 nt lds
    buffer_load_dwordx4 v30, s[32:35], s53 offen offset:2048 nt lds
    buffer_load_dwordx4 v31, s[32:35], s53 offen offset:3072 nt lds
    s_add_u32 s53, s53, 16384
L_ig_5:
    v_mfma_f32_4x4x4_16b_bf16 v[160:163], v[112:113], v[64:65], v[160:163] cbsz:4 abid:0
    v_mfma_f32_4x4x4_16b_bf16 v[164:167], v[112:113], v[66:67], v[164:167] cbsz:4 abid:0
    v_mfma_f32_4x4x4_16b_bf16 v[168:171], v[112:113], v[68:69], v[168:171] cbsz:4 abid:0
    v_mfma_f32_4x4x4_16b_bf16 v[172:175], v[112:113], v[70:71], v[172:175] cbsz:4 abid:0
    v_mfma_f32_4x4x4_16b_bf16 v[160:163], v[112:113], v[72:73], v[160:163] cbsz:4 abid:4
    v_mfma_f32_4x4x4_16b_bf16 v[164:167], v[112:113], v[74:75], v[164:167] cbsz:4 abid:4
    v_mfma_f32_4x4x4_16b_bf16 v[168:171], v[112:113], v[76:77], v[168:171] cbsz:4 abid:4
    v_mfma_f32_4x4x4_16b_bf16 v[172:175], v[112:113], v[78:79], v[172:175] cbsz:4 abid:4
    v_mfma_f32_4x4x4_16b_bf16 v[160:163], v[112:113], v[80:81], v[160:163] cbsz:4 abid:8
    v_mfma_f32_4x4x4_16b_bf16 v[164:167], v[112:113], v[82:83], v[164:167] cbsz:4 abid:8
    v_mfma_f32_4x4x4_16b_bf16 v[168:171], v[112:113], v[84:85], v[168:171] cbsz:4 abid:8
    v_mfma_f32_4x4x4_16b_bf16 v[172:175], v[112:113], v[86:87], v[172:175] cbsz:4 abid:8
    v_mfma_f32_4x4x4_16b_bf16 v[160:163], v[112:113], v[88:89], v[160:163] cbsz:4 abid:12
    v_mfma_f32_4x4x4_16b_bf16 v[164:167], v[112:113], v[90:91], v[164:167] cbsz:4 abid:12
    v_mfma_f32_4x4x4_16b_bf16 v[168:171], v[112:113], v[92:93], v[168:171] cbsz:4 abid:12
    v_mfma_f32_4x4x4_16b_bf16 v[172:175], v[112:113], v[94:95], v[172:175] cbsz:4 abid:12
    s_mov_b32 s56, s64
    s_cmp_eq_u32 s56, 1
    s_cbranch_scc1 L_wc_7
    s_waitcnt vmcnt(16)
    s_branch L_we_6
L_wc_7:
    s_waitcnt vmcnt(24)
L_we_6:
    ds_read_b64_tr_b16 v[64:65], v20 offset:8192
    ds_read_b64_tr_b16 v[66:67], v21 offset:8192
    ds_read_b64_tr_b16 v[68:69], v20 offset:8448
    ds_read_b64_tr_b16 v[70:71], v21 offset:8448
    ds_read_b64_tr_b16 v[72:73], v20 offset:10240
    ds_read_b64_tr_b16 v[74:75], v21 offset:10240
    ds_read_b64_tr_b16 v[76:77], v20 offset:10496
    ds_read_b64_tr_b16 v[78:79], v21 offset:10496
    ds_read_b64_tr_b16 v[80:81], v20 offset:12288
    ds_read_b64_tr_b16 v[82:83], v21 offset:12288
    ds_read_b64_tr_b16 v[84:85], v20 offset:12544
    ds_read_b64_tr_b16 v[86:87], v21 offset:12544
    s_waitcnt lgkmcnt(6)
    ds_read_b64_tr_b16 v[88:89], v20 offset:14336
    ds_read_b64_tr_b16 v[90:91], v21 offset:14336
    ds_read_b64_tr_b16 v[92:93], v20 offset:14592
    ds_read_b64_tr_b16 v[94:95], v21 offset:14592
    s_waitcnt lgkmcnt(0)
    s_cmp_eq_u32 s65, 0
    s_cbranch_scc1 L_ig_8
    s_add_u32 m0, s49, 8192
    s_nop 0
    buffer_load_dwordx4 v28, s[32:35], s53 offen offset:0 nt lds
    buffer_load_dwordx4 v29, s[32:35], s53 offen offset:1024 nt lds
    buffer_load_dwordx4 v30, s[32:35], s53 offen offset:2048 nt lds
    buffer_load_dwordx4 v31, s[32:35], s53 offen offset:3072 nt lds
    s_add_u32 s53, s53, 16384
    s_add_u32 m0, s49, 12288
    s_nop 0
    buffer_load_dwordx4 v28, s[32:35], s53 offen offset:0 nt lds
    buffer_load_dwordx4 v29, s[32:35], s53 offen offset:1024 nt lds
    buffer_load_dwordx4 v30, s[32:35], s53 offen offset:2048 nt lds
    buffer_load_dwordx4 v31, s[32:35], s53 offen offset:3072 nt lds
    s_add_u32 s53, s53, 16384
L_ig_8:
    v_mfma_f32_4x4x4_16b_bf16 v[160:163], v[114:115], v[64:65], v[160:163] cbsz:4 abid:0
    v_mfma_f32_4x4x4_16b_bf16 v[164:167], v[114:115], v[66:67], v[164:167] cbsz:4 abid:0
    v_mfma_f32_4x4x4_16b_bf16 v[168:171], v[114:115], v[68:69], v[168:171] cbsz:4 abid:0
    v_mfma_f32_4x4x4_16b_bf16 v[172:175], v[114:115], v[70:71], v[172:175] cbsz:4 abid:0
    v_mfma_f32_4x4x4_16b_bf16 v[160:163], v[114:115], v[72:73], v[160:163] cbsz:4 abid:4
    v_mfma_f32_4x4x4_16b_bf16 v[164:167], v[114:115], v[74:75], v[164:167] cbsz:4 abid:4
    v_mfma_f32_4x4x4_16b_bf16 v[168:171], v[114:115], v[76:77], v[168:171] cbsz:4 abid:4
    v_mfma_f32_4x4x4_16b_bf16 v[172:175], v[114:115], v[78:79], v[172:175] cbsz:4 abid:4
    v_mfma_f32_4x4x4_16b_bf16 v[160:163], v[114:115], v[80:81], v[160:163] cbsz:4 abid:8
    v_mfma_f32_4x4x4_16b_bf16 v[164:167], v[114:115], v[82:83], v[164:167] cbsz:4 abid:8
    v_mfma_f32_4x4x4_16b_bf16 v[168:171], v[114:115], v[84:85], v[168:171] cbsz:4 abid:8
    v_mfma_f32_4x4x4_16b_bf16 v[172:175], v[114:115], v[86:87], v[172:175] cbsz:4 abid:8
    v_mfma_f32_4x4x4_16b_bf16 v[160:163], v[114:115], v[88:89], v[160:163] cbsz:4 abid:12
    v_mfma_f32_4x4x4_16b_bf16 v[164:167], v[114:115], v[90:91], v[164:167] cbsz:4 abid:12
    v_mfma_f32_4x4x4_16b_bf16 v[168:171], v[114:115], v[92:93], v[168:171] cbsz:4 abid:12
    v_mfma_f32_4x4x4_16b_bf16 v[172:175], v[114:115], v[94:95], v[172:175] cbsz:4 abid:12
    s_add_u32 s56, s64, s65
    s_cmp_eq_u32 s56, 2
    s_cbranch_scc1 L_wc_10
    s_cmp_eq_u32 s56, 1
    s_cbranch_scc1 L_wc_11
    s_waitcnt vmcnt(8)
    s_branch L_we_9
L_wc_10:
    s_waitcnt vmcnt(24)
    s_branch L_we_9
L_wc_11:
    s_waitcnt vmcnt(16)
L_we_9:
    ds_read_b64_tr_b16 v[64:65], v20 offset:16384
    ds_read_b64_tr_b16 v[66:67], v21 offset:16384
    ds_read_b64_tr_b16 v[68:69], v20 offset:16640
    ds_read_b64_tr_b16 v[70:71], v21 offset:16640
    ds_read_b64_tr_b16 v[72:73], v20 offset:18432
    ds_read_b64_tr_b16 v[74:75], v21 offset:18432
    ds_read_b64_tr_b16 v[76:77], v20 offset:18688
    ds_read_b64_tr_b16 v[78:79], v21 offset:18688
    ds_read_b64_tr_b16 v[80:81], v20 offset:20480
    ds_read_b64_tr_b16 v[82:83], v21 offset:20480
    ds_read_b64_tr_b16 v[84:85], v20 offset:20736
    ds_read_b64_tr_b16 v[86:87], v21 offset:20736
    s_waitcnt lgkmcnt(6)
    ds_read_b64_tr_b16 v[88:89], v20 offset:22528
    ds_read_b64_tr_b16 v[90:91], v21 offset:22528
    ds_read_b64_tr_b16 v[92:93], v20 offset:22784
    ds_read_b64_tr_b16 v[94:95], v21 offset:22784
    s_waitcnt lgkmcnt(0)
    s_cmp_eq_u32 s66, 0
    s_cbranch_scc1 L_ig_12
    s_add_u32 m0, s49, 16384
    s_nop 0
    buffer_load_dwordx4 v28, s[32:35], s53 offen offset:0 nt lds
    buffer_load_dwordx4 v29, s[32:35], s53 offen offset:1024 nt lds
    buffer_load_dwordx4 v30, s[32:35], s53 offen offset:2048 nt lds
    buffer_load_dwordx4 v31, s[32:35], s53 offen offset:3072 nt lds
    s_add_u32 s53, s53, 16384
    s_add_u32 m0, s49, 20480
    s_nop 0
    buffer_load_dwordx4 v28, s[32:35], s53 offen offset:0 nt lds
    buffer_load_dwordx4 v29, s[32:35], s53 offen offset:1024 nt lds
    buffer_load_dwordx4 v30, s[32:35], s53 offen offset:2048 nt lds
    buffer_load_dwordx4 v31, s[32:35], s53 offen offset:3072 nt lds
    s_add_u32 s53, s53, 16384
L_ig_12:
    v_mfma_f32_4x4x4_16b_bf16 v[160:163], v[116:117], v[64:65], v[160:163] cbsz:4 abid:0
    v_mfma_f32_4x4x4_16b_bf16 v[164:167], v[116:117], v[66:67], v[164:167] cbsz:4 abid:0
    v_mfma_f32_4x4x4_16b_bf16 v[168:171], v[116:117], v[68:69], v[168:171] cbsz:4 abid:0
    v_mfma_f32_4x4x4_16b_bf16 v[172:175], v[116:117], v[70:71], v[172:175] cbsz:4 abid:0
    v_mfma_f32_4x4x4_16b_bf16 v[160:163], v[116:117], v[72:73], v[160:163] cbsz:4 abid:4
    v_mfma_f32_4x4x4_16b_bf16 v[164:167], v[116:117], v[74:75], v[164:167] cbsz:4 abid:4
    v_mfma_f32_4x4x4_16b_bf16 v[168:171], v[116:117], v[76:77], v[168:171] cbsz:4 abid:4
    v_mfma_f32_4x4x4_16b_bf16 v[172:175], v[116:117], v[78:79], v[172:175] cbsz:4 abid:4
    v_mfma_f32_4x4x4_16b_bf16 v[160:163], v[116:117], v[80:81], v[160:163] cbsz:4 abid:8
    v_mfma_f32_4x4x4_16b_bf16 v[164:167], v[116:117], v[82:83], v[164:167] cbsz:4 abid:8
    v_mfma_f32_4x4x4_16b_bf16 v[168:171], v[116:117], v[84:85], v[168:171] cbsz:4 abid:8
    v_mfma_f32_4x4x4_16b_bf16 v[172:175], v[116:117], v[86:87], v[172:175] cbsz:4 abid:8
    v_mfma_f32_4x4x4_16b_bf16 v[160:163], v[116:117], v[88:89], v[160:163] cbsz:4 abid:12
    v_mfma_f32_4x4x4_16b_bf16 v[164:167], v[116:117], v[90:91], v[164:167] cbsz:4 abid:12
    v_mfma_f32_4x4x4_16b_bf16 v[168:171], v[116:117], v[92:93], v[168:171] cbsz:4 abid:12
    v_mfma_f32_4x4x4_16b_bf16 v[172:175], v[116:117], v[94:95], v[172:175] cbsz:4 abid:12
    s_add_u32 s56, s64, s65
    s_add_u32 s56, s56, s66
    s_cmp_eq_u32 s56, 3
    s_cbranch_scc1 L_wc_14
    s_cmp_eq_u32 s56, 2
    s_cbranch_scc1 L_wc_15
    s_cmp_eq_u32 s56, 1
    s_cbranch_scc1 L_wc_16
    s_waitcnt vmcnt(0)
    s_branch L_we_13
L_wc_14:
    s_waitcnt vmcnt(24)
    s_branch L_we_13
L_wc_15:
    s_waitcnt vmcnt(16)
    s_branch L_we_13
L_wc_16:
    s_waitcnt vmcnt(8)
L_we_13:
    ds_read_b64_tr_b16 v[64:65], v20 offset:24576
    ds_read_b64_tr_b16 v[66:67], v21 offset:24576
    ds_read_b64_tr_b16 v[68:69], v20 offset:24832
    ds_read_b64_tr_b16 v[70:71], v21 offset:24832
    ds_read_b64_tr_b16 v[72:73], v20 offset:26624
    ds_read_b64_tr_b16 v[74:75], v21 offset:26624
    ds_read_b64_tr_b16 v[76:77], v20 offset:26880
    ds_read_b64_tr_b16 v[78:79], v21 offset:26880
    ds_read_b64_tr_b16 v[80:81], v20 offset:28672
    ds_read_b64_tr_b16 v[82:83], v21 offset:28672
    ds_read_b64_tr_b16 v[84:85], v20 offset:28928
    ds_read_b64_tr_b16 v[86:87], v21 offset:28928
    s_waitcnt lgkmcnt(6)
    ds_read_b64_tr_b16 v[88:89], v20 offset:30720
    ds_read_b64_tr_b16 v[90:91], v21 offset:30720
    ds_read_b64_tr_b16 v[92:93], v20 offset:30976
    ds_read_b64_tr_b16 v[94:95], v21 offset:30976
    s_waitcnt lgkmcnt(0)
    s_cmp_eq_u32 s67, 0
    s_cbranch_scc1 L_ig_17
    s_add_u32 m0, s49, 24576
    s_nop 0
    buffer_load_dwordx4 v28, s[32:35], s53 offen offset:0 nt lds
    buffer_load_dwordx4 v29, s[32:35], s53 offen offset:1024 nt lds
    buffer_load_dwordx4 v30, s[32:35], s53 offen offset:2048 nt lds
    buffer_load_dwordx4 v31, s[32:35], s53 offen offset:3072 nt lds
    s_add_u32 s53, s53, 16384
    s_add_u32 m0, s49, 28672
    s_nop 0
    buffer_load_dwordx4 v28, s[32:35], s53 offen offset:0 nt lds
    buffer_load_dwordx4 v29, s[32:35], s53 offen offset:1024 nt lds
    buffer_load_dwordx4 v30, s[32:35], s53 offen offset:2048 nt lds
    buffer_load_dwordx4 v31, s[32:35], s53 offen offset:3072 nt lds
    s_add_u32 s53, s53, 16384
L_ig_17:
    v_mfma_f32_4x4x4_16b_bf16 v[160:163], v[118:119], v[64:65], v[160:163] cbsz:4 abid:0
    v_mfma_f32_4x4x4_16b_bf16 v[164:167], v[118:119], v[66:67], v[164:167] cbsz:4 abid:0
    v_mfma_f32_4x4x4_16b_bf16 v[168:171], v[118:119], v[68:69], v[168:171] cbsz:4 abid:0
    v_mfma_f32_4x4x4_16b_bf16 v[172:175], v[118:119], v[70:71], v[172:175] cbsz:4 abid:0
    v_mfma_f32_4x4x4_16b_bf16 v[160:163], v[118:119], v[72:73], v[160:163] cbsz:4 abid:4
    v_mfma_f32_4x4x4_16b_bf16 v[164:167], v[118:119], v[74:75], v[164:167] cbsz:4 abid:4
    v_mfma_f32_4x4x4_16b_bf16 v[168:171], v[118:119], v[76:77], v[168:171] cbsz:4 abid:4
    v_mfma_f32_4x4x4_16b_bf16 v[172:175], v[118:119], v[78:79], v[172:175] cbsz:4 abid:4
    v_mfma_f32_4x4x4_16b_bf16 v[160:163], v[118:119], v[80:81], v[160:163] cbsz:4 abid:8
    v_mfma_f32_4x4x4_16b_bf16 v[164:167], v[118:119], v[82:83], v[164:167] cbsz:4 abid:8
    v_mfma_f32_4x4x4_16b_bf16 v[168:171], v[118:119], v[84:85], v[168:171] cbsz:4 abid:8
    v_mfma_f32_4x4x4_16b_bf16 v[172:175], v[118:119], v[86:87], v[172:175] cbsz:4 abid:8
    v_mfma_f32_4x4x4_16b_bf16 v[160:163], v[118:119], v[88:89], v[160:163] cbsz:4 abid:12
    v_mfma_f32_4x4x4_16b_bf16 v[164:167], v[118:119], v[90:91], v[164:167] cbsz:4 abid:12
    v_mfma_f32_4x4x4_16b_bf16 v[168:171], v[118:119], v[92:93], v[168:171] cbsz:4 abid:12
    v_mfma_f32_4x4x4_16b_bf16 v[172:175], v[118:119], v[94:95], v[172:175] cbsz:4 abid:12
    s_cmp_eq_u32 s64, 0
    s_cbranch_scc1 L_sk_18
    s_add_u32 s56, s65, s66
    s_add_u32 s56, s56, s67
    s_cmp_eq_u32 s56, 3
    s_cbranch_scc1 L_wc_20
    s_cmp_eq_u32 s56, 2
    s_cbranch_scc1 L_wc_21
    s_cmp_eq_u32 s56, 1
    s_cbranch_scc1 L_wc_22
    s_waitcnt vmcnt(0)
    s_branch L_we_19
L_wc_20:
    s_waitcnt vmcnt(24)
    s_branch L_we_19
L_wc_21:
    s_waitcnt vmcnt(16)
    s_branch L_we_19
L_wc_22:
    s_waitcnt vmcnt(8)
L_we_19:
    ds_read_b64_tr_b16 v[64:65], v20 offset:0
    ds_read_b64_tr_b16 v[66:67], v21 offset:0
    ds_read_b64_tr_b16 v[68:69], v20 offset:256
    ds_read_b64_tr_b16 v[70:71], v21 offset:256
    ds_read_b64_tr_b16 v[72:73], v20 offset:2048
    ds_read_b64_tr_b16 v[74:75], v21 offset:2048
    ds_read_b64_tr_b16 v[76:77], v20 offset:2304
    ds_read_b64_tr_b16 v[78:79], v21 offset:2304
    ds_read_b64_tr_b16 v[80:81], v20 offset:4096
    ds_read_b64_tr_b16 v[82:83], v21 offset:4096
    ds_read_b64_tr_b16 v[84:85], v20 offset:4352
    ds_read_b64_tr_b16 v[86:87], v21 offset:4352
    s_waitcnt lgkmcnt(6)
    ds_read_b64_tr_b16 v[88:89], v20 offset:6144
    ds_read_b64_tr_b16 v[90:91], v21 offset:6144
    ds_read_b64_tr_b16 v[92:93], v20 offset:6400
    ds_read_b64_tr_b16 v[94:95], v21 offset:6400
    s_waitcnt lgkmcnt(0)
L_sk_18:
    s_cmp_eq_u32 s70, 0
    s_cbranch_scc1 L_ig_23
    s_sub_u32 s53, s68, 0
    s_add_u32 m0, s49, 0
    s_nop 0
    buffer_load_dwordx4 v28, s[32:35], s53 offen offset:0 nt lds
    buffer_load_dwordx4 v29, s[32:35], s53 offen offset:1024 nt lds
    buffer_load_dwordx4 v30, s[32:35], s53 offen offset:2048 nt lds
    buffer_load_dwordx4 v31, s[32:35], s53 offen offset:3072 nt lds
    s_add_u32 s53, s53, 16384
    s_add_u32 m0, s49, 4096
    s_nop 0
    buffer_load_dwordx4 v28, s[32:35], s53 offen offset:0 nt lds
    buffer_load_dwordx4 v29, s[32:35], s53 offen offset:1024 nt lds
    buffer_load_dwordx4 v30, s[32:35], s53 offen offset:2048 nt lds
    buffer_load_dwordx4 v31, s[32:35], s53 offen offset:3072 nt lds
    s_add_u32 s53, s53, 16384
L_ig_23:
    s_cmp_eq_u32 s64, 0
    s_cbranch_scc1 L_sk_24
    v_mfma_f32_4x4x4_16b_bf16 v[160:163], v[120:121], v[64:65], v[160:163] cbsz:4 abid:0
    v_mfma_f32_4x4x4_16b_bf16 v[164:167], v[120:121], v[66:67], v[164:167] cbsz:4 abid:0
    v_mfma_f32_4x4x4_16b_bf16 v[168:171], v[120:121], v[68:69], v[168:171] cbsz:4 abid:0
    v_mfma_f32_4x4x4_16b_bf16 v[172:175], v[120:121], v[70:71], v[172:175] cbsz:4 abid:0
    v_mfma_f32_4x4x4_16b_bf16 v[160:163], v[120:121], v[72:73], v[160:163] cbsz:4 abid:4
    v_mfma_f32_4x4x4_16b_bf16 v[164:167], v[120:121], v[74:75], v[164:167] cbsz:4 abid:4
    v_mfma_f32_4x4x4_16b_bf16 v[168:171], v[120:121], v[76:77], v[168:171] cbsz:4 abid:4
    v_mfma_f32_4x4x4_16b_bf16 v[172:175], v[120:121], v[78:79], v[172:175] cbsz:4 abid:4
    v_mfma_f32_4x4x4_16b_bf16 v[160:163], v[120:121], v[80:81], v[160:163] cbsz:4 abid:8
    v_mfma_f32_4x4x4_16b_bf16 v[164:167], v[120:121], v[82:83], v[164:167] cbsz:4 abid:8
    v_mfma_f32_4x4x4_16b_bf16 v[168:171], v[120:121], v[84:85], v[168:171] cbsz:4 abid:8
    v_mfma_f32_4x4x4_16b_bf16 v[172:175], v[120:121], v[86:87], v[172:175] cbsz:4 abid:8
    v_mfma_f32_4x4x4_16b_bf16 v[160:163], v[120:121], v[88:89], v[160:163] cbsz:4 abid:12
    v_mfma_f32_4x4x4_16b_bf16 v[164:167], v[120:121], v[90:91], v[164:167] cbsz:4 abid:12
    v_mfma_f32_4x4x4_16b_bf16 v[168:171], v[120:121], v[92:93], v[168:171] cbsz:4 abid:12
    v_mfma_f32_4x4x4_16b_bf16 v[172:175], v[120:121], v[94:95], v[172:175] cbsz:4 abid:12
L_sk_24:
    s_cmp_eq_u32 s65, 0
    s_cbranch_scc1 L_sk_25
    s_add_u32 s56, s66, s67
    s_add_u32 s56, s56, s70
    s_cmp_eq_u32 s56, 3
    s_cbranch_scc1 L_wc_27
    s_cmp_eq_u32 s56, 2
    s_cbranch_scc1 L_wc_28
    s_cmp_eq_u32 s56, 1
    s_cbranch_scc1 L_wc_29
    s_waitcnt vmcnt(0)
    s_branch L_we_26
L_wc_27:
    s_waitcnt vmcnt(24)
    s_branch L_we_26
L_wc_28:
    s_waitcnt vmcnt(16)
    s_branch L_we_26
L_wc_29:
    s_waitcnt vmcnt(8)
L_we_26:
    ds_read_b64_tr_b16 v[64:65], v20 offset:8192
    ds_read_b64_tr_b16 v[66:67], v21 offset:8192
    ds_read_b64_tr_b16 v[68:69], v20 offset:8448
    ds_read_b64_tr_b16 v[70:71], v21 offset:8448
    ds_read_b64_tr_b16 v[72:73], v20 offset:10240
    ds_read_b64_tr_b16 v[74:75], v21 offset:10240
    ds_read_b64_tr_b16 v[76:77], v20 offset:10496
    ds_read_b64_tr_b16 v[78:79], v21 offset:10496
    ds_read_b64_tr_b16 v[80:81], v20 offset:12288
    ds_read_b64_tr_b16 v[82:83], v21 offset:12288
    ds_read_b64_tr_b16 v[84:85], v20 offset:12544
    ds_read_b64_tr_b16 v[86:87], v21 offset:12544
    s_waitcnt lgkmcnt(6)
    ds_read_b64_tr_b16 v[88:89], v20 offset:14336
    ds_read_b64_tr_b16 v[90:91], v21 offset:14336
    ds_read_b64_tr_b16 v[92:93], v20 offset:14592
    ds_read_b64_tr_b16 v[94:95], v21 offset:14592
    s_waitcnt lgkmcnt(0)
L_sk_25:
    s_cmp_eq_u32 s71, 0
    s_cbranch_scc1 L_ig_30
    s_sub_u32 s53, s68, 32768
    s_add_u32 m0, s49, 8192
    s_nop 0
    buffer_load_dwordx4 v28, s[32:35], s53 offen offset:0 nt lds
    buffer_load_dwordx4 v29, s[32:35], s53 offen offset:1024 nt lds
    buffer_load_dwordx4 v30, s[32:35], s53 offen offset:2048 nt lds
    buffer_load_dwordx4 v31, s[32:35], s53 offen offset:3072 nt lds
    s_add_u32 s53, s53, 16384
    s_add_u32 m0, s49, 12288
    s_nop 0
    buffer_load_dwordx4 v28, s[32:35], s53 offen offset:0 nt lds
    buffer_load_dwordx4 v29, s[32:35], s53 offen offset:1024 nt lds
    buffer_load_dwordx4 v30, s[32:35], s53 offen offset:2048 nt lds
    buffer_load_dwordx4 v31, s[32:35], s53 offen offset:3072 nt lds
    s_add_u32 s53, s53, 16384
L_ig_30:
    s_cmp_eq_u32 s65, 0
    s_cbranch_scc1 L_sk_31
    v_mfma_f32_4x4x4_16b_bf16 v[160:163], v[122:123], v[64:65], v[160:163] cbsz:4 abid:0
    v_mfma_f32_4x4x4_16b_bf16 v[164:167], v[122:123], v[66:67], v[164:167] cbsz:4 abid:0
    v_mfma_f32_4x4x4_16b_bf16 v[168:171], v[122:123], v[68:69], v[168:171] cbsz:4 abid:0
    v_mfma_f32_4x4x4_16b_bf16 v[172:175], v[122:123], v[70:71], v[172:175] cbsz:4 abid:0
    v_mfma_f32_4x4x4_16b_bf16 v[160:163], v[122:123], v[72:73], v[160:163] cbsz:4 abid:4
    v_mfma_f32_4x4x4_16b_bf16 v[164:167], v[122:123], v[74:75], v[164:167] cbsz:4 abid:4
    v_mfma_f32_4x4x4_16b_bf16 v[168:171], v[122:123], v[76:77], v[168:171] cbsz:4 abid:4
    v_mfma_f32_4x4x4_16b_bf16 v[172:175], v[122:123], v[78:79], v[172:175] cbsz:4 abid:4
    v_mfma_f32_4x4x4_16b_bf16 v[160:163], v[122:123], v[80:81], v[160:163] cbsz:4 abid:8
    v_mfma_f32_4x4x4_16b_bf16 v[164:167], v[122:123], v[82:83], v[164:167] cbsz:4 abid:8
    v_mfma_f32_4x4x4_16b_bf16 v[168:171], v[122:123], v[84:85], v[168:171] cbsz:4 abid:8
    v_mfma_f32_4x4x4_16b_bf16 v[172:175], v[122:123], v[86:87], v[172:175] cbsz:4 abid:8
    v_mfma_f32_4x4x4_16b_bf16 v[160:163], v[122:123], v[88:89], v[160:163] cbsz:4 abid:12
    v_mfma_f32_4x4x4_16b_bf16 v[164:167], v[122:123], v[90:91], v[164:167] cbsz:4 abid:12
    v_mfma_f32_4x4x4_16b_bf16 v[168:171], v[122:123], v[92:93], v[168:171] cbsz:4 abid:12
    v_mfma_f32_4x4x4_16b_bf16 v[172:175], v[122:123], v[94:95], v[172:175] cbsz:4 abid:12
L_sk_31:
    s_cmp_eq_u32 s66, 0
    s_cbranch_scc1 L_sk_32
    s_add_u32 s56, s67, s70
    s_add_u32 s56, s56, s71
    s_cmp_eq_u32 s56, 3
    s_cbranch_scc1 L_wc_34
    s_cmp_eq_u32 s56, 2
    s_cbranch_scc1 L_wc_35
    s_cmp_eq_u32 s56, 1
    s_cbranch_scc1 L_wc_36
    s_waitcnt vmcnt(0)
    s_branch L_we_33
L_wc_34:
    s_waitcnt vmcnt(24)
    s_branch L_we_33
L_wc_35:
    s_waitcnt vmcnt(16)
    s_branch L_we_33
L_wc_36:
    s_waitcnt vmcnt(8)
L_we_33:
    ds_read_b64_tr_b16 v[64:65], v20 offset:16384
    ds_read_b64_tr_b16 v[66:67], v21 offset:16384
    ds_read_b64_tr_b16 v[68:69], v20 offset:16640
    ds_read_b64_tr_b16 v[70:71], v21 offset:16640
    ds_read_b64_tr_b16 v[72:73], v20 offset:18432
    ds_read_b64_tr_b16 v[74:75], v21 offset:18432
    ds_read_b64_tr_b16 v[76:77], v20 offset:18688
    ds_read_b64_tr_b16 v[78:79], v21 offset:18688
    ds_read_b64_tr_b16 v[80:81], v20 offset:20480
    ds_read_b64_tr_b16 v[82:83], v21 offset:20480
    ds_read_b64_tr_b16 v[84:85], v20 offset:20736
    ds_read_b64_tr_b16 v[86:87], v21 offset:20736
    s_waitcnt lgkmcnt(6)
    ds_read_b64_tr_b16 v[88:89], v20 offset:22528
    ds_read_b64_tr_b16 v[90:91], v21 offset:22528
    ds_read_b64_tr_b16 v[92:93], v20 offset:22784
    ds_read_b64_tr_b16 v[94:95], v21 offset:22784
    s_waitcnt lgkmcnt(0)
L_sk_32:
    s_cmp_eq_u32 s72, 0
    s_cbranch_scc1 L_ig_37
    s_sub_u32 s53, s68, 65536
    s_add_u32 m0, s49, 16384
    s_nop 0
    buffer_load_dwordx4 v28, s[32:35], s53 offen offset:0 nt lds
    buffer_load_dwordx4 v29, s[32:35], s53 offen offset:1024 nt lds
    buffer_load_dwordx4 v30, s[32:35], s53 offen offset:2048 nt lds
    buffer_load_dwordx4 v31, s[32:35], s53 offen offset:3072 nt lds
    s_add_u32 s53, s53, 16384
    s_add_u32 m0, s49, 20480
    s_nop 0
    buffer_load_dwordx4 v28, s[32:35], s53 offen offset:0 nt lds
    buffer_load_dwordx4 v29, s[32:35], s53 offen offset:1024 nt lds
    buffer_load_dwordx4 v30, s[32:35], s53 offen offset:2048 nt lds
    buffer_load_dwordx4 v31, s[32:35], s53 offen offset:3072 nt lds
    s_add_u32 s53, s53, 16384
L_ig_37:
    s_cmp_eq_u32 s66, 0
    s_cbranch_scc1 L_sk_38
    v_mfma_f32_4x4x4_16b_bf16 v[160:163], v[124:125], v[64:65], v[160:163] cbsz:4 abid:0
    v_mfma_f32_4x4x4_16b_bf16 v[164:167], v[124:125], v[66:67], v[164:167] cbsz:4 abid:0
    v_mfma_f32_4x4x4_16b_bf16 v[168:171], v[124:125], v[68:69], v[168:171] cbsz:4 abid:0
    v_mfma_f32_4x4x4_16b_bf16 v[172:175], v[124:125], v[70:71], v[172:175] cbsz:4 abid:0
    v_mfma_f32_4x4x4_16b_bf16 v[160:163], v[124:125], v[72:73], v[160:163] cbsz:4 abid:4
    v_mfma_f32_4x4x4_16b_bf16 v[164:167], v[124:125], v[74:75], v[164:167] cbsz:4 abid:4
    v_mfma_f32_4x4x4_16b_bf16 v[168:171], v[124:125], v[76:77], v[168:171] cbsz:4 abid:4
    v_mfma_f32_4x4x4_16b_bf16 v[172:175], v[124:125], v[78:79], v[172:175] cbsz:4 abid:4
    v_mfma_f32_4x4x4_16b_bf16 v[160:163], v[124:125], v[80:81], v[160:163] cbsz:4 abid:8
    v_mfma_f32_4x4x4_16b_bf16 v[164:167], v[124:125], v[82:83], v[164:167] cbsz:4 abid:8
    v_mfma_f32_4x4x4_16b_bf16 v[168:171], v[124:125], v[84:85], v[168:171] cbsz:4 abid:8
    v_mfma_f32_4x4x4_16b_bf16 v[172:175], v[124:125], v[86:87], v[172:175] cbsz:4 abid:8
    v_mfma_f32_4x4x4_16b_bf16 v[160:163], v[124:125], v[88:89], v[160:163] cbsz:4 abid:12
    v_mfma_f32_4x4x4_16b_bf16 v[164:167], v[124:125], v[90:91], v[164:167] cbsz:4 abid:12
    v_mfma_f32_4x4x4_16b_bf16 v[168:171], v[124:125], v[92:93], v[168:171] cbsz:4 abid:12
    v_mfma_f32_4x4x4_16b_bf16 v[172:175], v[124:125], v[94:95], v[172:175] cbsz:4 abid:12
L_sk_38:
    s_cmp_eq_u32 s67, 0
    s_cbranch_scc1 L_sk_39
    s_add_u32 s56, s70, s71
    s_add_u32 s56, s56, s72
    s_cmp_eq_u32 s56, 3
    s_cbranch_scc1 L_wc_41
    s_cmp_eq_u32 s56, 2
    s_cbranch_scc1 L_wc_42
    s_cmp_eq_u32 s56, 1
    s_cbranch_scc1 L_wc_43
    s_waitcnt vmcnt(0)
    s_branch L_we_40
L_wc_41:
    s_waitcnt vmcnt(24)
    s_branch L_we_40
L_wc_42:
    s_waitcnt vmcnt(16)
    s_branch L_we_40
L_wc_43:
    s_waitcnt vmcnt(8)
L_we_40:
    ds_read_b64_tr_b16 v[64:65], v20 offset:24576
    ds_read_b64_tr_b16 v[66:67], v21 offset:24576
    ds_read_b64_tr_b16 v[68:69], v20 offset:24832
    ds_read_b64_tr_b16 v[70:71], v21 offset:24832
    ds_read_b64_tr_b16 v[72:73], v20 offset:26624
    ds_read_b64_tr_b16 v[74:75], v21 offset:26624
    ds_read_b64_tr_b16 v[76:77], v20 offset:26880
    ds_read_b64_tr_b16 v[78:79], v21 offset:26880
    ds_read_b64_tr_b16 v[80:81], v20 offset:28672
    ds_read_b64_tr_b16 v[82:83], v21 offset:28672
    ds_read_b64_tr_b16 v[84:85], v20 offset:28928
    ds_read_b64_tr_b16 v[86:87], v21 offset:28928
    s_waitcnt lgkmcnt(6)
    ds_read_b64_tr_b16 v[88:89], v20 offset:30720
    ds_read_b64_tr_b16 v[90:91], v21 offset:30720
    ds_read_b64_tr_b16 v[92:93], v20 offset:30976
    ds_read_b64_tr_b16 v[94:95], v21 offset:30976
    s_waitcnt lgkmcnt(0)
L_sk_39:
    s_cmp_eq_u32 s73, 0
    s_cbranch_scc1 L_ig_44
    s_sub_u32 s53, s68, 98304
    s_add_u32 m0, s49, 24576
    s_nop 0
    buffer_load_dwordx4 v28, s[32:35], s53 offen offset:0 nt lds
    buffer_load_dwordx4 v29, s[32:35], s53 offen offset:1024 nt lds
    buffer_load_dwordx4 v30, s[32:35], s53 offen offset:2048 nt lds
    buffer_load_dwordx4 v31, s[32:35], s53 offen offset:3072 nt lds
    s_add_u32 s53, s53, 16384
    s_add_u32 m0, s49, 28672
    s_nop 0
    buffer_load_dwordx4 v28, s[32:35], s53 offen offset:0 nt lds
    buffer_load_dwordx4 v29, s[32:35], s53 offen offset:1024 nt lds
    buffer_load_dwordx4 v30, s[32:35], s53 offen offset:2048 nt lds
    buffer_load_dwordx4 v31, s[32:35], s53 offen offset:3072 nt lds
    s_add_u32 s53, s53, 16384
L_ig_44:
    s_cmp_eq_u32 s67, 0
    s_cbranch_scc1 L_sk_45
    v_mfma_f32_4x4x4_16b_bf16 v[160:163], v[126:127], v[64:65], v[160:163] cbsz:4 abid:0
    v_mfma_f32_4x4x4_16b_bf16 v[164:167], v[126:127], v[66:67], v[164:167] cbsz:4 abid:0
    v_mfma_f32_4x4x4_16b_bf16 v[168:171], v[126:127], v[68:69], v[168:171] cbsz:4 abid:0
    v_mfma_f32_4x4x4_16b_bf16 v[172:175], v[126:127], v[70:71], v[172:175] cbsz:4 abid:0
    v_mfma_f32_4x4x4_16b_bf16 v[160:163], v[126:127], v[72:73], v[160:163] cbsz:4 abid:4
    v_mfma_f32_4x4x4_16b_bf16 v[164:167], v[126:127], v[74:75], v[164:167] cbsz:4 abid:4
    v_mfma_f32_4x4x4_16b_bf16 v[168:171], v[126:127], v[76:77], v[168:171] cbsz:4 abid:4
    v_mfma_f32_4x4x4_16b_bf16 v[172:175], v[126:127], v[78:79], v[172:175] cbsz:4 abid:4
    v_mfma_f32_4x4x4_16b_bf16 v[160:163], v[126:127], v[80:81], v[160:163] cbsz:4 abid:8
    v_mfma_f32_4x4x4_16b_bf16 v[164:167], v[126:127], v[82:83], v[164:167] cbsz:4 abid:8
    v_mfma_f32_4x4x4_16b_bf16 v[168:171], v[126:127], v[84:85], v[168:171] cbsz:4 abid:8
    v_mfma_f32_4x4x4_16b_bf16 v[172:175], v[126:127], v[86:87], v[172:175] cbsz:4 abid:8
    v_mfma_f32_4x4x4_16b_bf16 v[160:163], v[126:127], v[88:89], v[160:163] cbsz:4 abid:12
    v_mfma_f32_4x4x4_16b_bf16 v[164:167], v[126:127], v[90:91], v[164:167] cbsz:4 abid:12
    v_mfma_f32_4x4x4_16b_bf16 v[168:171], v[126:127], v[92:93], v[168:171] cbsz:4 abid:12
    v_mfma_f32_4x4x4_16b_bf16 v[172:175], v[126:127], v[94:95], v[172:175] cbsz:4 abid:12
L_sk_45:
    s_cmp_eq_u32 s72, 0
    s_cbranch_scc0 L_ws_46
    s_mov_b32 exec_hi, 0x00ffffff
    ds_write_b128 v15, v[176:179] offset:16384
    ds_write_b128 v15, v[180:183] offset:17312
    ds_write_b128 v15, v[184:187] offset:18240
    ds_write_b128 v15, v[188:191] offset:19168
    ds_write_b128 v15, v[192:195] offset:20096
    ds_write_b128 v15, v[196:199] offset:21024
    ds_write_b128 v15, v[200:203] offset:21952
    ds_write_b128 v15, v[204:207] offset:22880
    ds_write_b128 v15, v[208:211] offset:23808
    ds_write_b128 v15, v[212:215] offset:24736
    ds_write_b128 v15, v[216:219] offset:25664
    ds_write_b128 v15, v[220:223] offset:26592
    s_waitcnt lgkmcnt(6)
    ds_write_b128 v15, v[224:227] offset:27520
    ds_write_b128 v15, v[228:231] offset:28448
    ds_write_b128 v15, v[232:235] offset:29376
    ds_write_b128 v15, v[236:239] offset:30304
    s_mov_b64 exec, -1
L_ws_46:
    s_cmp_eq_u32 s70, 0
    s_cbranch_scc1 L_sk_47
    s_add_u32 s56, s71, s72
    s_add_u32 s56, s56, s73
    s_cmp_eq_u32 s56, 3
    s_cbranch_scc1 L_wc_49
    s_cmp_eq_u32 s56, 2
    s_cbranch_scc1 L_wc_50
    s_cmp_eq_u32 s56, 1
    s_cbranch_scc1 L_wc_51
    s_waitcnt vmcnt(0)
    s_branch L_we_48
L_wc_49:
    s_waitcnt vmcnt(24)
    s_branch L_we_48
L_wc_50:
    s_waitcnt vmcnt(16)
    s_branch L_we_48
L_wc_51:
    s_waitcnt vmcnt(8)
L_we_48:
    ds_read_b64_tr_b16 v[64:65], v20 offset:0
    ds_read_b64_tr_b16 v[66:67], v21 offset:0
    ds_read_b64_tr_b16 v[68:69], v20 offset:256
    ds_read_b64_tr_b16 v[70:71], v21 offset:256
    ds_read_b64_tr_b16 v[72:73], v20 offset:2048
    ds_read_b64_tr_b16 v[74:75], v21 offset:2048
    ds_read_b64_tr_b16 v[76:77], v20 offset:2304
    ds_read_b64_tr_b16 v[78:79], v21 offset:2304
    ds_read_b64_tr_b16 v[80:81], v20 offset:4096
    ds_read_b64_tr_b16 v[82:83], v21 offset:4096
    ds_read_b64_tr_b16 v[84:85], v20 offset:4352
    ds_read_b64_tr_b16 v[86:87], v21 offset:4352
    s_waitcnt lgkmcnt(6)
    ds_read_b64_tr_b16 v[88:89], v20 offset:6144
    ds_read_b64_tr_b16 v[90:91], v21 offset:6144
    ds_read_b64_tr_b16 v[92:93], v20 offset:6400
    ds_read_b64_tr_b16 v[94:95], v21 offset:6400
    s_mov_b32 s96, 800000
L_lw_52:
    ds_read_b32 v2, v9 offset:52
    s_waitcnt lgkmcnt(0)
    v_readfirstlane_b32 s56, v2
    s_sub_u32 s96, s96, 1
    s_cbranch_scc1 L_lwd_53
    s_cmp_ge_u32 s56, 1
    s_cbranch_scc0 L_lw_52
L_lwd_53:
    ds_read_b64 v[246:247], v7 offset:192
    s_waitcnt lgkmcnt(0)
L_sk_47:
    s_cmp_eq_u32 s70, 0
    s_cbranch_scc1 L_sk_54
    v_mfma_f32_4x4x4_16b_bf16 v[160:163], v[246:247], v[64:65], v[160:163] cbsz:4 abid:0
    v_mfma_f32_4x4x4_16b_bf16 v[164:167], v[246:247], v[66:67], v[164:167] cbsz:4 abid:0
    v_mfma_f32_4x4x4_16b_bf16 v[168:171], v[246:247], v[68:69], v[168:171] cbsz:4 abid:0
    v_mfma_f32_4x4x4_16b_bf16 v[172:175], v[246:247], v[70:71], v[172:175] cbsz:4 abid:0
    v_mfma_f32_4x4x4_16b_bf16 v[160:163], v[246:247], v[72:73], v[160:163] cbsz:4 abid:4
    v_mfma_f32_4x4x4_16b_bf16 v[164:167], v[246:247], v[74:75], v[164:167] cbsz:4 abid:4
    v_mfma_f32_4x4x4_16b_bf16 v[168:171], v[246:247], v[76:77], v[168:171] cbsz:4 abid:4
    v_mfma_f32_4x4x4_16b_bf16 v[172:175], v[246:247], v[78:79], v[172:175] cbsz:4 abid:4
    v_mfma_f32_4x4x4_16b_bf16 v[160:163], v[246:247], v[80:81], v[160:163] cbsz:4 abid:8
    v_mfma_f32_4x4x4_16b_bf16 v[164:167], v[246:247], v[82:83], v[164:167] cbsz:4 abid:8
    v_mfma_f32_4x4x4_16b_bf16 v[168:171], v[246:247], v[84:85], v[168:171] cbsz:4 abid:8
    v_mfma_f32_4x4x4_16b_bf16 v[172:175], v[246:247], v[86:87], v[172:175] cbsz:4 abid:8
    v_mfma_f32_4x4x4_16b_bf16 v[160:163], v[246:247], v[88:89], v[160:163] cbsz:4 abid:12
    v_mfma_f32_4x4x4_16b_bf16 v[164:167], v[246:247], v[90:91], v[164:167] cbsz:4 abid:12
    v_mfma_f32_4x4x4_16b_bf16 v[168:171], v[246:247], v[92:93], v[168:171] cbsz:4 abid:12
    v_mfma_f32_4x4x4_16b_bf16 v[172:175], v[246:247], v[94:95], v[172:175] cbsz:4 abid:12
L_sk_54:
    s_cmp_eq_u32 s71, 0
    s_cbranch_scc1 L_sk_55
    s_add_u32 s56, s72, s73
    s_cmp_eq_u32 s56, 2
    s_cbranch_scc1 L_wc_57
    s_cmp_eq_u32 s56, 1
    s_cbranch_scc1 L_wc_58
    s_waitcnt vmcnt(0)
    s_branch L_we_56
L_wc_57:
    s_waitcnt vmcnt(16)
    s_branch L_we_56
L_wc_58:
    s_waitcnt vmcnt(8)
L_we_56:
    ds_read_b64_tr_b16 v[64:65], v20 offset:8192
    ds_read_b64_tr_b16 v[66:67], v21 offset:8192
    ds_read_b64_tr_b16 v[68:69], v20 offset:8448
    ds_read_b64_tr_b16 v[70:71], v21 offset:8448
    ds_read_b64_tr_b16 v[72:73], v20 offset:10240
    ds_read_b64_tr_b16 v[74:75], v21 offset:10240
    ds_read_b64_tr_b16 v[76:77], v20 offset:10496
    ds_read_b64_tr_b16 v[78:79], v21 offset:10496
    ds_read_b64_tr_b16 v[80:81], v20 offset:12288
    ds_read_b64_tr_b16 v[82:83], v21 offset:12288
    ds_read_b64_tr_b16 v[84:85], v20 offset:12544
    ds_read_b64_tr_b16 v[86:87], v21 offset:12544
    s_waitcnt lgkmcnt(6)
    ds_read_b64_tr_b16 v[88:89], v20 offset:14336
    ds_read_b64_tr_b16 v[90:91], v21 offset:14336
    ds_read_b64_tr_b16 v[92:93], v20 offset:14592
    ds_read_b64_tr_b16 v[94:95], v21 offset:14592
    s_mov_b32 s96, 800000
L_lw_59:
    ds_read_b32 v2, v9 offset:52
    s_waitcnt lgkmcnt(0)
    v_readfirstlane_b32 s56, v2
    s_sub_u32 s96, s96, 1
    s_cbranch_scc1 L_lwd_60
    s_cmp_ge_u32 s56, 1
    s_cbranch_scc0 L_lw_59
L_lwd_60:
    ds_read_b64 v[246:247], v7 offset:128
    s_waitcnt lgkmcnt(0)
L_sk_55:
    s_cmp_eq_u32 s71, 0
    s_cbranch_scc1 L_sk_61
    v_mfma_f32_4x4x4_16b_bf16 v[160:163], v[246:247], v[64:65], v[160:163] cbsz:4 abid:0
    v_mfma_f32_4x4x4_16b_bf16 v[164:167], v[246:247], v[66:67], v[164:167] cbsz:4 abid:0
    v_mfma_f32_4x4x4_16b_bf16 v[168:171], v[246:247], v[68:69], v[168:171] cbsz:4 abid:0
    v_mfma_f32_4x4x4_16b_bf16 v[172:175], v[246:247], v[70:71], v[172:175] cbsz:4 abid:0
    v_mfma_f32_4x4x4_16b_bf16 v[160:163], v[246:247], v[72:73], v[160:163] cbsz:4 abid:4
    v_mfma_f32_4x4x4_16b_bf16 v[164:167], v[246:247], v[74:75], v[164:167] cbsz:4 abid:4
    v_mfma_f32_4x4x4_16b_bf16 v[168:171], v[246:247], v[76:77], v[168:171] cbsz:4 abid:4
    v_mfma_f32_4x4x4_16b_bf16 v[172:175], v[246:247], v[78:79], v[172:175] cbsz:4 abid:4
    v_mfma_f32_4x4x4_16b_bf16 v[160:163], v[246:247], v[80:81], v[160:163] cbsz:4 abid:8
    v_mfma_f32_4x4x4_16b_bf16 v[164:167], v[246:247], v[82:83], v[164:167] cbsz:4 abid:8
    v_mfma_f32_4x4x4_16b_bf16 v[168:171], v[246:247], v[84:85], v[168:171] cbsz:4 abid:8
    v_mfma_f32_4x4x4_16b_bf16 v[172:175], v[246:247], v[86:87], v[172:175] cbsz:4 abid:8
    v_mfma_f32_4x4x4_16b_bf16 v[160:163], v[246:247], v[88:89], v[160:163] cbsz:4 abid:12
    v_mfma_f32_4x4x4_16b_bf16 v[164:167], v[246:247], v[90:91], v[164:167] cbsz:4 abid:12
    v_mfma_f32_4x4x4_16b_bf16 v[168:171], v[246:247], v[92:93], v[168:171] cbsz:4 abid:12
    v_mfma_f32_4x4x4_16b_bf16 v[172:175], v[246:247], v[94:95], v[172:175] cbsz:4 abid:12
L_sk_61:
    s_cmp_eq_u32 s72, 0
    s_cbranch_scc1 L_sk_62
    s_mov_b32 s56, s73
    s_cmp_eq_u32 s56, 1
    s_cbranch_scc1 L_wc_64
    s_waitcnt vmcnt(0)
    s_branch L_we_63
L_wc_64:
    s_waitcnt vmcnt(8)
L_we_63:
    ds_read_b64_tr_b16 v[64:65], v20 offset:16384
    ds_read_b64_tr_b16 v[66:67], v21 offset:16384
    ds_read_b64_tr_b16 v[68:69], v20 offset:16640
    ds_read_b64_tr_b16 v[70:71], v21 offset:16640
    ds_read_b64_tr_b16 v[72:73], v20 offset:18432
    ds_read_b64_tr_b16 v[74:75], v21 offset:18432
    ds_read_b64_tr_b16 v[76:77], v20 offset:18688
    ds_read_b64_tr_b16 v[78:79], v21 offset:18688
    ds_read_b64_tr_b16 v[80:81], v20 offset:20480
    ds_read_b64_tr_b16 v[82:83], v21 offset:20480
    ds_read_b64_tr_b16 v[84:85], v20 offset:20736
    ds_read_b64_tr_b16 v[86:87], v21 offset:20736
    s_waitcnt lgkmcnt(6)
    ds_read_b64_tr_b16 v[88:89], v20 offset:22528
    ds_read_b64_tr_b16 v[90:91], v21 offset:22528
    ds_read_b64_tr_b16 v[92:93], v20 offset:22784
    ds_read_b64_tr_b16 v[94:95], v21 offset:22784
    s_mov_b32 s96, 800000
L_lw_65:
    ds_read_b32 v2, v9 offset:52
    s_waitcnt lgkmcnt(0)
    v_readfirstlane_b32 s56, v2
    s_sub_u32 s96, s96, 1
    s_cbranch_scc1 L_lwd_66
    s_cmp_ge_u32 s56, 1
    s_cbranch_scc0 L_lw_65
L_lwd_66:
    ds_read_b64 v[246:247], v7 offset:64
    s_waitcnt lgkmcnt(0)
L_sk_62:
    s_cmp_eq_u32 s72, 0
    s_cbranch_scc1 L_sk_67
    v_mfma_f32_4x4x4_16b_bf16 v[160:163], v[246:247], v[64:65], v[160:163] cbsz:4 abid:0
    v_mfma_f32_4x4x4_16b_bf16 v[164:167], v[246:247], v[66:67], v[164:167] cbsz:4 abid:0
    v_mfma_f32_4x4x4_16b_bf16 v[168:171], v[246:247], v[68:69], v[168:171] cbsz:4 abid:0
    v_mfma_f32_4x4x4_16b_bf16 v[172:175], v[246:247], v[70:71], v[172:175] cbsz:4 abid:0
    v_mfma_f32_4x4x4_16b_bf16 v[160:163], v[246:247], v[72:73], v[160:163] cbsz:4 abid:4
    v_mfma_f32_4x4x4_16b_bf16 v[164:167], v[246:247], v[74:75], v[164:167] cbsz:4 abid:4
    v_mfma_f32_4x4x4_16b_bf16 v[168:171], v[246:247], v[76:77], v[168:171] cbsz:4 abid:4
    v_mfma_f32_4x4x4_16b_bf16 v[172:175], v[246:247], v[78:79], v[172:175] cbsz:4 abid:4
    v_mfma_f32_4x4x4_16b_bf16 v[160:163], v[246:247], v[80:81], v[160:163] cbsz:4 abid:8
    v_mfma_f32_4x4x4_16b_bf16 v[164:167], v[246:247], v[82:83], v[164:167] cbsz:4 abid:8
    v_mfma_f32_4x4x4_16b_bf16 v[168:171], v[246:247], v[84:85], v[168:171] cbsz:4 abid:8
    v_mfma_f32_4x4x4_16b_bf16 v[172:175], v[246:247], v[86:87], v[172:175] cbsz:4 abid:8
    v_mfma_f32_4x4x4_16b_bf16 v[160:163], v[246:247], v[88:89], v[160:163] cbsz:4 abid:12
    v_mfma_f32_4x4x4_16b_bf16 v[164:167], v[246:247], v[90:91], v[164:167] cbsz:4 abid:12
    v_mfma_f32_4x4x4_16b_bf16 v[168:171], v[246:247], v[92:93], v[168:171] cbsz:4 abid:12
    v_mfma_f32_4x4x4_16b_bf16 v[172:175], v[246:247], v[94:95], v[172:175] cbsz:4 abid:12
L_sk_67:
    s_cmp_eq_u32 s73, 0
    s_cbranch_scc1 L_sk_68
    s_waitcnt vmcnt(0)
    ds_read_b64_tr_b16 v[64:65], v20 offset:24576
    ds_read_b64_tr_b16 v[66:67], v21 offset:24576
    ds_read_b64_tr_b16 v[68:69], v20 offset:24832
    ds_read_b64_tr_b16 v[70:71], v21 offset:24832
    ds_read_b64_tr_b16 v[72:73], v20 offset:26624
    ds_read_b64_tr_b16 v[74:75], v21 offset:26624
    ds_read_b64_tr_b16 v[76:77], v20 offset:26880
    ds_read_b64_tr_b16 v[78:79], v21 offset:26880
    ds_read_b64_tr_b16 v[80:81], v20 offset:28672
    ds_read_b64_tr_b16 v[82:83], v21 offset:28672
    ds_read_b64_tr_b16 v[84:85], v20 offset:28928
    ds_read_b64_tr_b16 v[86:87], v21 offset:28928
    s_waitcnt lgkmcnt(6)
    ds_read_b64_tr_b16 v[88:89], v20 offset:30720
    ds_read_b64_tr_b16 v[90:91], v21 offset:30720
    ds_read_b64_tr_b16 v[92:93], v20 offset:30976
    ds_read_b64_tr_b16 v[94:95], v21 offset:30976
    s_mov_b32 s96, 800000
L_lw_69:
    ds_read_b32 v2, v9 offset:52
    s_waitcnt lgkmcnt(0)
    v_readfirstlane_b32 s56, v2
    s_sub_u32 s96, s96, 1
    s_cbranch_scc1 L_lwd_70
    s_cmp_ge_u32 s56, 1
    s_cbranch_scc0 L_lw_69
L_lwd_70:
    ds_read_b64 v[246:247], v7 offset:0
    s_waitcnt lgkmcnt(0)
L_sk_68:
    s_cmp_eq_u32 s73, 0
    s_cbranch_scc1 L_sk_71
    v_mfma_f32_4x4x4_16b_bf16 v[160:163], v[246:247], v[64:65], v[160:163] cbsz:4 abid:0
    v_mfma_f32_4x4x4_16b_bf16 v[164:167], v[246:247], v[66:67], v[164:167] cbsz:4 abid:0
    v_mfma_f32_4x4x4_16b_bf16 v[168:171], v[246:247], v[68:69], v[168:171] cbsz:4 abid:0
    v_mfma_f32_4x4x4_16b_bf16 v[172:175], v[246:247], v[70:71], v[172:175] cbsz:4 abid:0
    v_mfma_f32_4x4x4_16b_bf16 v[160:163], v[246:247], v[72:73], v[160:163] cbsz:4 abid:4
    v_mfma_f32_4x4x4_16b_bf16 v[164:167], v[246:247], v[74:75], v[164:167] cbsz:4 abid:4
    v_mfma_f32_4x4x4_16b_bf16 v[168:171], v[246:247], v[76:77], v[168:171] cbsz:4 abid:4
    v_mfma_f32_4x4x4_16b_bf16 v[172:175], v[246:247], v[78:79], v[172:175] cbsz:4 abid:4
    v_mfma_f32_4x4x4_16b_bf16 v[160:163], v[246:247], v[80:81], v[160:163] cbsz:4 abid:8
    v_mfma_f32_4x4x4_16b_bf16 v[164:167], v[246:247], v[82:83], v[164:167] cbsz:4 abid:8
    v_mfma_f32_4x4x4_16b_bf16 v[168:171], v[246:247], v[84:85], v[168:171] cbsz:4 abid:8
    v_mfma_f32_4x4x4_16b_bf16 v[172:175], v[246:247], v[86:87], v[172:175] cbsz:4 abid:8
    v_mfma_f32_4x4x4_16b_bf16 v[160:163], v[246:247], v[88:89], v[160:163] cbsz:4 abid:12
    v_mfma_f32_4x4x4_16b_bf16 v[164:167], v[246:247], v[90:91], v[164:167] cbsz:4 abid:12
    v_mfma_f32_4x4x4_16b_bf16 v[168:171], v[246:247], v[92:93], v[168:171] cbsz:4 abid:12
    v_mfma_f32_4x4x4_16b_bf16 v[172:175], v[246:247], v[94:95], v[172:175] cbsz:4 abid:12
L_sk_71:
    s_cmp_eq_u32 s72, 1
    s_cbranch_scc0 L_ws_72
    s_mov_b32 exec_hi, 0x00ffffff
    ds_write_b128 v15, v[176:179] offset:16384
    ds_write_b128 v15, v[180:183] offset:17312
    ds_write_b128 v15, v[184:187] offset:18240
    ds_write_b128 v15, v[188:191] offset:19168
    ds_write_b128 v15, v[192:195] offset:20096
    ds_write_b128 v15, v[196:199] offset:21024
    ds_write_b128 v15, v[200:203] offset:21952
    ds_write_b128 v15, v[204:207] offset:22880
    ds_write_b128 v15, v[208:211] offset:23808
    ds_write_b128 v15, v[212:215] offset:24736
    ds_write_b128 v15, v[216:219] offset:25664
    ds_write_b128 v15, v[220:223] offset:26592
    s_waitcnt lgkmcnt(6)
    ds_write_b128 v15, v[224:227] offset:27520
    ds_write_b128 v15, v[228:231] offset:28448
    ds_write_b128 v15, v[232:235] offset:29376
    ds_write_b128 v15, v[236:239] offset:30304
    s_mov_b64 exec, -1
L_ws_72:
    s_nop 4
    ds_write2st64_b32 v6, v160, v161 offset0:0 offset1:4
    ds_write2st64_b32 v6, v164, v165 offset0:1 offset1:5
    ds_write2st64_b32 v6, v168, v169 offset0:2 offset1:6
    ds_write2st64_b32 v6, v172, v173 offset0:3 offset1:7
    s_mov_b64 exec, 1
    v_mov_b32 v2, 1
    ds_add_u32 v9, v2 offset:56
    s_mov_b64 exec, -1
L_tail:
    s_waitcnt lgkmcnt(0)
    s_barrier
    s_cmp_eq_u32 s3, 0
    s_cbranch_scc1 L_t1_done
    s_cmp_gt_u32 s3, 2
    s_cbranch_scc1 L_t1_other
    ds_read_b128 v[32:35], v205
    ds_read_b128 v[36:39], v205 offset:32768
    ds_read_b128 v[40:43], v206
    ds_read_b128 v[44:47], v206 offset:32768
    s_waitcnt lgkmcnt(3)
    v_mul_f32 v32, v192, v32
    v_mul_f32 v33, v192, v33
    v_mul_f32 v34, v192, v34
    v_mul_f32 v35, v192, v35
    s_waitcnt lgkmcnt(2)
    v_fmac_f32 v32, v193, v36
    v_fmac_f32 v33, v193, v37
    v_fmac_f32 v34, v193, v38
    v_fmac_f32 v35, v193, v39
    s_waitcnt lgkmcnt(1)
    v_fmac_f32 v32, v194, v40
    v_fmac_f32 v33, v194, v41
    v_fmac_f32 v34, v194, v42
    v_fmac_f32 v35, v194, v43
    s_waitcnt lgkmcnt(0)
    v_fmac_f32 v32, v195, v44
    v_fmac_f32 v33, v195, v45
    v_fmac_f32 v34, v195, v46
    v_fmac_f32 v35, v195, v47
    v_perm_b32 v32, v32, v35, s70
    v_perm_b32 v33, v33, v35, s71
    v_perm_b32 v34, v34, v35, s72
    v_mov_b32 v35, v200
    buffer_store_dwordx4 v[32:35], v207, s[36:39], s82 offen sc1
    s_cmp_lg_u32 s3, 1
    s_cbranch_scc1 L_t1_done
    v_mov_b32 v4, 0
    s_mov_b64 exec, 1
    buffer_store_dwordx4 v[32:35], v4, s[36:39], s84 offen sc1
    s_mov_b64 exec, -1
    s_branch L_t1_done
L_t1_other:
    v_mov_b32 v9, 151040
    ds_read_b32 v200, v9 offset:8
L_t1_done:
    s_setprio 0
    s_mov_b32 s70, 0x07060503
    s_mov_b32 s71, 0x07060502
    s_mov_b32 s72, 0x07060501
    s_mov_b32 s73, 0x04000c0c
    s_mov_b32 s74, 0x0706000c
    s_cmp_eq_u32 s3, 0
    s_cbranch_scc1 L_t2_w0
    s_sub_u32 s87, s3, 1
    v_lshrrev_b32 v6, 2, v1
    v_mul_u32_u24 v6, 928, v6
    v_and_b32 v7, 3, v1
    v_lshlrev_b32 v7, 3, v7
    v_add_u32 v6, v6, v7
    s_lshl_b32 s50, s87, 7
    v_add_u32 v6, s50, v6
    v_add_u32 v7, 65536, v6
    ds_read_b64_tr_b16 v[64:65], v6 offset:16384
    ds_read_b64_tr_b16 v[68:69], v6 offset:16416
    ds_read_b64_tr_b16 v[72:73], v6 offset:16448
    ds_read_b64_tr_b16 v[76:77], v6 offset:16480
    ds_read_b64_tr_b16 v[66:67], v6 offset:49152
    ds_read_b64_tr_b16 v[70:71], v6 offset:49184
    ds_read_b64_tr_b16 v[74:75], v6 offset:49216
    ds_read_b64_tr_b16 v[78:79], v6 offset:49248
    ds_read_b64_tr_b16 v[80:81], v7 offset:16384
    ds_read_b64_tr_b16 v[84:85], v7 offset:16416
    ds_read_b64_tr_b16 v[88:89], v7 offset:16448
    ds_read_b64_tr_b16 v[92:93], v7 offset:16480
    s_waitcnt lgkmcnt(6)
    ds_read_b64_tr_b16 v[82:83], v7 offset:49152
    ds_read_b64_tr_b16 v[86:87], v7 offset:49184
    ds_read_b64_tr_b16 v[90:91], v7 offset:49216
    ds_read_b64_tr_b16 v[94:95], v7 offset:49248
    v_lshrrev_b32 v26, 2, v1
    v_mul_u32_u24 v24, 928, v26
    v_and_b32 v25, 3, v1
    v_lshlrev_b32 v25, 3, v25
    s_lshl_b32 s50, s87, 7
    v_add_u32 v25, s50, v25
    v_add_u32 v24, v24, v25
    v_add_u32 v24, 131072, v24
    v_add_u32 v26, 16, v26
    v_min_u32 v26, 27, v26
    v_mul_u32_u24 v27, 928, v26
    v_add_u32 v27, v27, v25
    v_cmp_lt_u32 vcc, 20, v26
    v_add_u32 v25, 131072, v27
    v_add_u32 v27, 131808, v27
    v_cndmask_b32 v25, v25, v27, vcc
    s_waitcnt lgkmcnt(4)
    ds_read_b64_tr_b16 v[96:97], v24 offset:0
    ds_read_b64_tr_b16 v[100:101], v24 offset:32
    ds_read_b64_tr_b16 v[104:105], v24 offset:64
    ds_read_b64_tr_b16 v[108:109], v24 offset:96
    ds_read_b64_tr_b16 v[98:99], v25 offset:0
    ds_read_b64_tr_b16 v[102:103], v25 offset:32
    ds_read_b64_tr_b16 v[106:107], v25 offset:64
    ds_read_b64_tr_b16 v[110:111], v25 offset:96
    s_and_b32 s48, s61, 63
    s_lshl_b32 s49, s46, 6
    s_add_u32 s48, s48, s49
    s_mul_i32 s48, s48, 1792
    s_lshl_b32 s49, s87, 8
    s_add_u32 s48, s48, s49
    s_add_u32 s85, s48, 1114112
    v_lshrrev_b32 v28, 4, v1
    v_lshlrev_b32 v29, 3, v28
    v_add_u32 v29, 159552, v29
    v_lshlrev_b32 v28, 4, v28
    v_bfe_u32 v27, v1, 2, 2
    v_lshlrev_b32 v27, 6, v27
    v_add_u32 v28, v28, v27
    s_mov_b32 s76, 0x00f000f0
    s_mov_b32 s77, 0x00f000f0
    s_mov_b32 s78, 0x0f000f00
    s_mov_b32 s79, 0x0f000f00
    s_mov_b32 s80, 0xf000f000
    s_mov_b32 s81, 0xf000f000
    s_branch L_t2_done
L_t2_w0:
    s_mov_b32 s96, 40000
    s_cmp_eq_u32 s86, 1
    s_cbranch_scc1 L_t2_go
L_t2_pml:
    buffer_load_dwordx4 v[8:11], v206, s[36:39], s84 offen sc1
    s_waitcnt vmcnt(0)
    v_cmp_ne_u32 vcc, v11, v200
    s_sub_u32 s96, s96, 1
    s_cbranch_scc1 L_t2_go
    s_and_b32 s52, vcc_lo, 0xff
    s_bcnt1_i32_b32 s52, s52
    s_cmp_le_u32 s52, 2
    s_cbranch_scc1 L_t2_go
    s_sleep 4
    s_branch L_t2_pml
L_t2_go:
    buffer_load_dwordx4 v[216:219], v205, s[36:39], s82 offen sc1
    buffer_load_dwordx4 v[220:223], v205, s[36:39], s83 offen sc1
    s_sleep 6
L_t2_poll:
    buffer_load_dwordx4 v[224:227], v205, s[36:39], s82 offen sc1
    buffer_load_dwordx4 v[228:231], v205, s[36:39], s83 offen sc1
    s_waitcnt vmcnt(2)
    v_cmp_eq_u32 s[54:55], v219, v200
    v_cmp_eq_u32 vcc, v223, v200
    s_and_b64 s[54:55], s[54:55], vcc
    s_cmp_eq_u64 s[54:55], exec
    s_cbranch_scc1 L_t2_gotA
    s_sub_u32 s96, s96, 1
    s_cbranch_scc1 L_t2_gotA
    buffer_load_dwordx4 v[216:219], v205, s[36:39], s82 offen sc1
    buffer_load_dwordx4 v[220:223], v205, s[36:39], s83 offen sc1
    s_waitcnt vmcnt(2)
    v_cmp_eq_u32 s[54:55], v227, v200
    v_cmp_eq_u32 vcc, v231, v200
    s_and_b64 s[54:55], s[54:55], vcc
    s_cmp_eq_u64 s[54:55], exec
    s_cbranch_scc1 L_t2_gotB
    s_branch L_t2_poll
L_t2_gotB:
    v_perm_b32 v227, v224, v225, s73
    v_perm_b32 v227, v227, v226, s74
    v_perm_b32 v231, v228, v229, s73
    v_perm_b32 v231, v231, v230, s74
    v_mul_f32 v224, v211, v224
    v_mul_f32 v225, v211, v225
    v_mul_f32 v226, v211, v226
    v_mul_f32 v227, v211, v227
    v_fmac_f32 v224, v212, v228
    v_fmac_f32 v225, v212, v229
    v_fmac_f32 v226, v212, v230
    v_fmac_f32 v227, v212, v231
    v_mov_b32 v228, v224
    v_mov_b32 v229, v225
    v_mov_b32 v230, v226
    v_mov_b32 v231, v227
    v_permlane16_swap_b32 v224, v228
    v_permlane16_swap_b32 v225, v229
    v_permlane16_swap_b32 v226, v230
    v_permlane16_swap_b32 v227, v231
    v_add_f32 v224, v224, v228
    v_add_f32 v225, v225, v229
    v_add_f32 v226, v226, v230
    v_add_f32 v227, v227, v231
    v_mov_b32 v228, v224
    v_mov_b32 v229, v225
    v_mov_b32 v230, v226
    v_mov_b32 v231, v227
    v_permlane32_swap_b32 v224, v228
    v_permlane32_swap_b32 v225, v229
    v_permlane32_swap_b32 v226, v230
    v_permlane32_swap_b32 v227, v231
    v_add_f32 v224, v224, v228
    v_add_f32 v225, v225, v229
    v_add_f32 v226, v226, v230
    v_add_f32 v227, v227, v231
    v_cvt_pk_bf16_f32 v224, v224, v225
    v_cvt_pk_bf16_f32 v225, v226, v227
    s_mov_b64 exec, 0xffff
    ds_write_b64 v207, v[224:225]
    s_mov_b64 exec, -1
    s_branch L_t2_done
L_t2_gotA:
    v_perm_b32 v219, v216, v217, s73
    v_perm_b32 v219, v219, v218, s74
    v_perm_b32 v223, v220, v221, s73
    v_perm_b32 v223, v223, v222, s74
    v_mul_f32 v216, v211, v216
    v_mul_f32 v217, v211, v217
    v_mul_f32 v218, v211, v218
    v_mul_f32 v219, v211, v219
    v_fmac_f32 v216, v212, v220
    v_fmac_f32 v217, v212, v221
    v_fmac_f32 v218, v212, v222
    v_fmac_f32 v219, v212, v223
    v_mov_b32 v220, v216
    v_mov_b32 v221, v217
    v_mov_b32 v222, v218
    v_mov_b32 v223, v219
    v_permlane16_swap_b32 v216, v220
    v_permlane16_swap_b32 v217, v221
    v_permlane16_swap_b32 v218, v222
    v_permlane16_swap_b32 v219, v223
    v_add_f32 v216, v216, v220
    v_add_f32 v217, v217, v221
    v_add_f32 v218, v218, v222
    v_add_f32 v219, v219, v223
    v_mov_b32 v220, v216
    v_mov_b32 v221, v217
    v_mov_b32 v222, v218
    v_mov_b32 v223, v219
    v_permlane32_swap_b32 v216, v220
    v_permlane32_swap_b32 v217, v221
    v_permlane32_swap_b32 v218, v222
    v_permlane32_swap_b32 v219, v223
    v_add_f32 v216, v216, v220
    v_add_f32 v217, v217, v221
    v_add_f32 v218, v218, v222
    v_add_f32 v219, v219, v223
    v_cvt_pk_bf16_f32 v216, v216, v217
    v_cvt_pk_bf16_f32 v217, v218, v219
    s_mov_b64 exec, 0xffff
    ds_write_b64 v207, v[216:217]
    s_mov_b64 exec, -1
L_t2_done:
    s_waitcnt lgkmcnt(0)
    s_barrier
    s_cmp_eq_u32 s3, 0
    s_cbranch_scc1 L_t3_done
    ds_read_b64 v[8:9], v29 offset:0
    ds_read_b64 v[10:11], v29 offset:32
    ds_read_b64 v[12:13], v29 offset:64
    ds_read_b64 v[14:15], v29 offset:96
    ds_read_b64 v[16:17], v29 offset:128
    ds_read_b64 v[18:19], v29 offset:160
    s_waitcnt lgkmcnt(4)
    v_mfma_f32_16x16x32_bf16 v[32:35], v[64:67], v[8:11], 0
    v_mfma_f32_16x16x32_bf16 v[36:39], v[68:71], v[8:11], 0
    v_mfma_f32_16x16x32_bf16 v[40:43], v[72:75], v[8:11], 0
    v_mfma_f32_16x16x32_bf16 v[44:47], v[76:79], v[8:11], 0
    s_waitcnt lgkmcnt(2)
    v_mfma_f32_16x16x32_bf16 v[32:35], v[80:83], v[12:15], v[32:35]
    v_mfma_f32_16x16x32_bf16 v[36:39], v[84:87], v[12:15], v[36:39]
    v_mfma_f32_16x16x32_bf16 v[40:43], v[88:91], v[12:15], v[40:43]
    v_mfma_f32_16x16x32_bf16 v[44:47], v[92:95], v[12:15], v[44:47]
    s_waitcnt lgkmcnt(0)
    v_mfma_f32_16x16x32_bf16 v[32:35], v[96:99], v[16:19], v[32:35]
    v_mfma_f32_16x16x32_bf16 v[36:39], v[100:103], v[16:19], v[36:39]
    v_mfma_f32_16x16x32_bf16 v[40:43], v[104:107], v[16:19], v[40:43]
    v_mfma_f32_16x16x32_bf16 v[44:47], v[108:111], v[16:19], v[44:47]
    s_nop 7
    v_cndmask_b32 v48, v32, v36, s[76:77]
    v_cndmask_b32 v49, v33, v37, s[76:77]
    v_cndmask_b32 v50, v34, v38, s[76:77]
    v_cndmask_b32 v51, v35, v39, s[76:77]
    v_cndmask_b32 v48, v48, v40, s[78:79]
    v_cndmask_b32 v49, v49, v41, s[78:79]
    v_cndmask_b32 v50, v50, v42, s[78:79]
    v_cndmask_b32 v51, v51, v43, s[78:79]
    v_cndmask_b32 v48, v48, v44, s[80:81]
    v_cndmask_b32 v49, v49, v45, s[80:81]
    v_cndmask_b32 v50, v50, v46, s[80:81]
    v_cndmask_b32 v51, v51, v47, s[80:81]
    v_perm_b32 v48, v48, v51, s70
    v_perm_b32 v49, v49, v51, s71
    v_perm_b32 v50, v50, v51, s72
    v_mov_b32 v51, v200
    s_mov_b32 exec_lo, 0x11111111
    s_mov_b32 exec_hi, 0x11111111
    buffer_store_dwordx4 v[48:51], v28, s[36:39], s85 offen sc1
    s_mov_b64 exec, -1
L_t3_done:
    s_cmp_lg_u32 s47, s60
    s_cbranch_scc1 L_fin
    s_cmp_ge_u32 s60, 7
    s_cbranch_scc1 L_fin
    v_lshrrev_b32 v2, 4, v1
    v_mul_u32_u24 v2, 1792, v2
    v_and_b32 v3, 15, v1
    v_lshlrev_b32 v3, 4, v3
    v_add_u32 v2, v2, v3
    s_lshl_b32 s48, s46, 6
    s_lshl_b32 s49, s3, 3
    s_add_u32 s48, s48, s49
    s_mul_i32 s48, s48, 1792
    s_lshl_b32 s49, s60, 8
    s_add_u32 s48, s48, s49
    s_add_u32 s48, s48, 1114112
    s_add_u32 s49, s48, 7168
    s_mul_i32 s52, s46, 896
    s_lshl_b32 s53, s60, 7
    s_add_u32 s52, s52, s53
    v_lshlrev_b32 v5, 1, v1
    s_mov_b32 s28, s4
    s_mov_b32 s29, s5
    s_mov_b32 s30, 3584
    s_mov_b32 s31, 0x00020000
    buffer_load_ushort v24, v5, s[28:31], s52 offen
    s_mov_b32 s96, 40000
    buffer_load_dwordx4 v[32:35], v2, s[36:39], s48 offen sc1
    buffer_load_dwordx4 v[36:39], v2, s[36:39], s49 offen sc1
    s_sleep 6
L_t4_poll:
    buffer_load_dwordx4 v[40:43], v2, s[36:39], s48 offen sc1
    buffer_load_dwordx4 v[44:47], v2, s[36:39], s49 offen sc1
    s_waitcnt vmcnt(2)
    v_cmp_eq_u32 s[54:55], v35, v200
    v_cmp_eq_u32 vcc, v39, v200
    s_and_b64 s[54:55], s[54:55], vcc
    s_cmp_eq_u64 s[54:55], exec
    s_cbranch_scc1 L_t4_gotA
    s_sub_u32 s96, s96, 1
    s_cbranch_scc1 L_t4_gotA
    buffer_load_dwordx4 v[32:35], v2, s[36:39], s48 offen sc1
    buffer_load_dwordx4 v[36:39], v2, s[36:39], s49 offen sc1
    s_waitcnt vmcnt(2)
    v_cmp_eq_u32 s[54:55], v43, v200
    v_cmp_eq_u32 vcc, v47, v200
    s_and_b64 s[54:55], s[54:55], vcc
    s_cmp_eq_u64 s[54:55], exec
    s_cbranch_scc1 L_t4_gotB
    s_branch L_t4_poll
L_t4_gotB:
    v_perm_b32 v43, v40, v41, s73
    v_perm_b32 v43, v43, v42, s74
    v_perm_b32 v47, v44, v45, s73
    v_perm_b32 v47, v47, v46, s74
    v_add_f32 v8, v40, v44
    v_add_f32 v9, v41, v45
    v_add_f32 v10, v42, v46
    v_add_f32 v11, v43, v47
    s_branch L_t4_sum
L_t4_gotA:
    v_perm_b32 v35, v32, v33, s73
    v_perm_b32 v35, v35, v34, s74
    v_perm_b32 v39, v36, v37, s73
    v_perm_b32 v39, v39, v38, s74
    v_add_f32 v8, v32, v36
    v_add_f32 v9, v33, v37
    v_add_f32 v10, v34, v38
    v_add_f32 v11, v35, v39
L_t4_sum:
    v_mov_b32 v12, v8
    v_mov_b32 v13, v9
    v_mov_b32 v14, v10
    v_mov_b32 v15, v11
    v_permlane16_swap_b32 v8, v12
    v_permlane16_swap_b32 v9, v13
    v_permlane16_swap_b32 v10, v14
    v_permlane16_swap_b32 v11, v15
    v_add_f32 v8, v8, v12
    v_add_f32 v9, v9, v13
    v_add_f32 v10, v10, v14
    v_add_f32 v11, v11, v15
    v_mov_b32 v12, v8
    v_mov_b32 v13, v9
    v_mov_b32 v14, v10
    v_mov_b32 v15, v11
    v_permlane32_swap_b32 v8, v12
    v_permlane32_swap_b32 v9, v13
    v_permlane32_swap_b32 v10, v14
    v_permlane32_swap_b32 v11, v15
    v_add_f32 v8, v8, v12
    v_add_f32 v9, v9, v13
    v_add_f32 v10, v10, v14
    v_add_f32 v11, v11, v15
    s_lshl_b32 s48, s3, 8
    s_add_u32 s48, s48, 151296
    v_add_u32 v3, s48, v3
    s_mov_b64 exec, 0xffff
    ds_write_b128 v3, v[8:11]
    s_mov_b64 exec, -1
    s_waitcnt lgkmcnt(0)
    s_barrier
    s_cmp_lg_u32 s3, 0
    s_cbranch_scc1 L_fin
    v_lshlrev_b32 v2, 2, v1
    v_add_u32 v3, 151296, v2
    ds_read_b32 v8, v3 offset:0
    ds_read_b32 v9, v3 offset:256
    ds_read_b32 v10, v3 offset:512
    ds_read_b32 v11, v3 offset:768
    ds_read_b32 v12, v3 offset:1024
    ds_read_b32 v13, v3 offset:1280
    ds_read_b32 v14, v3 offset:1536
    ds_read_b32 v15, v3 offset:1792
    s_mov_b32 s28, s22
    s_mov_b32 s29, s23
    v_lshlrev_b32 v24, 16, v24
    s_waitcnt lgkmcnt(0)
    v_add_f32 v8, v8, v9
    v_add_f32 v10, v10, v11
    v_add_f32 v12, v12, v13
    v_add_f32 v14, v14, v15
    v_add_f32 v8, v8, v10
    v_add_f32 v12, v12, v14
    v_add_f32 v8, v8, v12
    v_add_f32 v8, v24, v8
    v_cvt_pk_bf16_f32 v8, v8, v8
    buffer_store_short v8, v5, s[28:31], s52 offen
    s_cmp_lg_u32 s2, 0
    s_cbranch_scc1 L_fin
    s_mov_b32 s52, 0xe8b2f51
    v_mul_lo_u32 v8, v200, s52
    v_mov_b32 v6, 0
    s_mov_b64 exec, 1
    buffer_store_dword v8, v6, s[36:39], 0 offen sc1
    s_mov_b64 exec, -1
L_fin:
L_end:
    s_endpgm
L_help:
    s_setprio 3
    v_lshlrev_b32 v3, 4, v1
    v_mov_b32 v4, 0x7ffffff0
    v_cmp_gt_u32 vcc, 56, v1
    v_mov_b32 v9, 151040
    v_mov_b32 v10, 0
    v_cndmask_b32 v4, v4, v3, vcc
    v_lshlrev_b32 v5, 2, v1
    v_add_u32 v5, 151040, v5
    v_lshrrev_b32 v236, 3, v1
    v_and_b32 v237, 7, v1
    v_lshlrev_b32 v237, 4, v237
    s_cmp_lg_u32 s3, 3
    s_cbranch_scc1 L_h_noz
    ds_write_b32 v5, v10
L_h_noz:
    s_mul_i32 s48, s3, 896
    s_waitcnt lgkmcnt(0)
    s_mov_b32 s28, s4
    s_mov_b32 s29, s5
    s_mov_b32 s30, 3584
    s_mov_b32 s31, 0x00020000
    buffer_load_dwordx4 v[56:59], v4, s[28:31], s48 offen
    s_cmp_eq_u32 s3, 0
    s_cbranch_scc1 L_h0_pre
    s_mov_b32 s36, s26
    s_mov_b32 s37, s27
    s_mov_b32 s38, 2359296
    s_mov_b32 s39, 0x00020000
    s_cmp_eq_u32 s3, 2
    s_cbranch_scc0 L_h_pf
    v_mov_b32 v6, 0
    buffer_load_dword v16, v6, s[36:39], 0 offen sc1
    s_branch L_h_ln
L_h_pf:
    s_branch L_h_ln
L_h0_pre:
    s_mov_b32 s40, s10
    s_mov_b32 s41, s11
    s_mov_b32 s42, 3670016
    s_mov_b32 s43, 0x00020000
    v_lshlrev_b32 v6, 13, v236
    v_add_u32 v6, v6, v237
    s_mul_i32 s49, s46, 917504
    s_lshl_b32 s50, s47, 10
    s_add_u32 s49, s49, s50
    s_lshl_b32 s50, s45, 7
    s_add_u32 s49, s49, s50
    s_mov_b32 m0, 131072
    s_add_u32 s50, s49, 0
    buffer_load_dwordx4 v6, s[40:43], s50 offen nt lds
    s_mov_b32 m0, 132096
    s_add_u32 s50, s49, 65536
    buffer_load_dwordx4 v6, s[40:43], s50 offen nt lds
    s_mov_b32 m0, 133120
    s_add_u32 s50, s49, 131072
    buffer_load_dwordx4 v6, s[40:43], s50 offen nt lds
    s_mov_b32 m0, 134144
    s_add_u32 s50, s49, 196608
    buffer_load_dwordx4 v6, s[40:43], s50 offen nt lds
    s_mov_b32 m0, 135168
    s_add_u32 s50, s49, 262144
    buffer_load_dwordx4 v6, s[40:43], s50 offen nt lds
    s_mov_b32 m0, 136192
    s_add_u32 s50, s49, 327680
    buffer_load_dwordx4 v6, s[40:43], s50 offen nt lds
    s_mov_b32 m0, 137216
    s_add_u32 s50, s49, 393216
    buffer_load_dwordx4 v6, s[40:43], s50 offen nt lds
    s_mov_b32 m0, 138240
    s_add_u32 s50, s49, 458752
    buffer_load_dwordx4 v6, s[40:43], s50 offen nt lds
    s_mov_b32 m0, 139264
    s_add_u32 s50, s49, 524288
    buffer_load_dwordx4 v6, s[40:43], s50 offen nt lds
    s_mov_b32 m0, 140288
    s_add_u32 s50, s49, 589824
    buffer_load_dwordx4 v6, s[40:43], s50 offen nt lds
    s_mov_b32 m0, 141312
    s_add_u32 s50, s49, 655360
    buffer_load_dwordx4 v6, s[40:43], s50 offen nt lds
    s_mov_b32 m0, 142336
    s_add_u32 s50, s49, 720896
    buffer_load_dwordx4 v6, s[40:43], s50 offen nt lds
    s_mov_b32 m0, 143360
    s_add_u32 s50, s49, 786432
    buffer_load_dwordx4 v6, s[40:43], s50 offen nt lds
    s_mov_b32 m0, 144384
    s_add_u32 s50, s49, 851968
    buffer_load_dwordx4 v6, s[40:43], s50 offen nt lds
    s_mov_b32 s36, s26
    s_mov_b32 s37, s27
    s_mov_b32 s38, 2359296
    s_mov_b32 s39, 0x00020000
L_h_ln:
    s_barrier
    s_lshr_b32 s52, s60, 1
    s_and_b32 s53, s60, 1
    s_cmp_eq_u32 s53, 0
    s_cbranch_scc0 L_h_odd
    s_lshl_b32 s62, s52, 5
    s_add_u32 s62, s62, s44
    s_mul_i32 s63, s52, 28
    s_add_u32 s63, s63, s44
    s_cmp_lt_u32 s44, 28
    s_cselect_b32 s63, s63, -1
    s_branch L_h_idx
L_h_odd:
    s_mul_i32 s62, s52, 24
    s_add_u32 s62, s62, s44
    s_add_u32 s62, s62, 128
    s_cmp_lt_u32 s44, 24
    s_cselect_b32 s62, s62, -1
    s_mov_b32 s63, -1
L_h_idx:
    v_lshrrev_b32 v6, 2, v1
    v_lshlrev_b32 v6, 7, v6
    v_and_b32 v8, 3, v1
    v_lshlrev_b32 v11, 3, v8
    v_add_u32 v6, v6, v11
    v_add_u32 v238, 131072, v6
    s_lshl_b32 s52, s3, 5
    v_add_u32 v19, s52, v238
    v_mul_u32_u24 v11, 896, v8
    v_lshrrev_b32 v8, 4, v1
    v_lshlrev_b32 v12, 4, v8
    v_lshlrev_b32 v8, 3, v8
    v_add_u32 v11, v11, v8
    v_add_u32 v11, 146432, v11
    s_mul_i32 s52, s46, 224
    v_add_u32 v18, s52, v11
    s_mov_b32 s70, 0x07060503
    s_mov_b32 s71, 0x07060502
    s_mov_b32 s72, 0x07060501
    s_mov_b32 s73, 0x04000c0c
    s_mov_b32 s74, 0x0706000c
    v_and_b32 v13, 15, v1
    v_lshlrev_b32 v14, 4, v13
    v_lshlrev_b32 v13, 8, v13
    v_add_u32 v13, v13, v12
    s_lshl_b32 s53, s3, 6
    s_add_u32 s53, s53, 159936
    v_add_u32 v13, s53, v13
    v_lshrrev_b32 v8, 4, v1
    v_lshlrev_b32 v8, 13, v8
    v_add_u32 v14, v14, v8
    s_lshl_b32 s58, s47, 15
    s_lshl_b32 s53, s45, 10
    s_add_u32 s58, s58, s53
    s_lshl_b32 s53, s46, 8
    s_add_u32 s58, s58, s53
    s_add_u32 s58, s58, 65536
    s_cmp_eq_u32 s3, 0
    s_cbranch_scc1 L_h_w14
    s_cmp_eq_u32 s3, 2
    s_cbranch_scc1 L_h_w2
    s_waitcnt vmcnt(0)
    s_branch L_h_w
L_h_w2:
    s_waitcnt vmcnt(1)
    s_branch L_h_w
L_h_w14:
    s_waitcnt vmcnt(14)
L_h_w:
    v_lshlrev_b32 v20, 16, v56
    v_and_b32 v21, 0xffff0000, v56
    v_lshlrev_b32 v22, 16, v57
    v_and_b32 v23, 0xffff0000, v57
    v_lshlrev_b32 v24, 16, v58
    v_and_b32 v25, 0xffff0000, v58
    v_lshlrev_b32 v26, 16, v59
    v_and_b32 v27, 0xffff0000, v59
    v_mov_b32 v28, 0
    v_mov_b32 v29, 0
    v_readfirstlane_b32 s52, v20
    s_mov_b32 exec_hi, 0x00ffffff
    s_nop 0
    v_subrev_f32 v32, s52, v20
    v_subrev_f32 v33, s52, v21
    v_subrev_f32 v34, s52, v22
    v_subrev_f32 v35, s52, v23
    v_subrev_f32 v36, s52, v24
    v_subrev_f32 v37, s52, v25
    v_subrev_f32 v38, s52, v26
    v_subrev_f32 v39, s52, v27
    v_add_f32 v28, v32, v33
    v_mul_f32 v29, v32, v32
    v_add_f32 v30, v34, v35
    v_fmac_f32 v29, v33, v33
    v_add_f32 v31, v36, v37
    v_fmac_f32 v29, v34, v34
    v_add_f32 v28, v28, v30
    v_fmac_f32 v29, v35, v35
    v_add_f32 v30, v38, v39
    v_fmac_f32 v29, v36, v36
    v_add_f32 v28, v28, v31
    v_fmac_f32 v29, v37, v37
    v_add_f32 v28, v28, v30
    v_fmac_f32 v29, v38, v38
    v_fmac_f32 v29, v39, v39
    s_mov_b64 exec, -1
    s_nop 0
    s_nop 0
    v_add_f32_dpp v28, v28, v28 row_ror:8 row_mask:0xf bank_mask:0xf
    v_add_f32_dpp v29, v29, v29 row_ror:8 row_mask:0xf bank_mask:0xf
    s_nop 0
    v_add_f32_dpp v28, v28, v28 row_ror:4 row_mask:0xf bank_mask:0xf
    v_add_f32_dpp v29, v29, v29 row_ror:4 row_mask:0xf bank_mask:0xf
    s_nop 0
    v_add_f32_dpp v28, v28, v28 row_ror:2 row_mask:0xf bank_mask:0xf
    v_add_f32_dpp v29, v29, v29 row_ror:2 row_mask:0xf bank_mask:0xf
    s_nop 0
    v_add_f32_dpp v28, v28, v28 row_ror:1 row_mask:0xf bank_mask:0xf
    v_add_f32_dpp v29, v29, v29 row_ror:1 row_mask:0xf bank_mask:0xf
    v_mov_b32 v30, v28
    v_mov_b32 v31, v29
    s_nop 1
    v_permlane16_swap_b32 v28, v30
    v_permlane16_swap_b32 v29, v31
    s_nop 1
    v_add_f32 v28, v28, v30
    v_add_f32 v29, v29, v31
    v_mov_b32 v30, v28
    v_mov_b32 v31, v29
    s_nop 1
    v_permlane32_swap_b32 v28, v30
    v_permlane32_swap_b32 v29, v31
    s_nop 1
    v_add_f32 v28, v28, v30
    v_add_f32 v29, v29, v31
    v_mul_f32 v28, 0x3b124925, v28
    v_mul_f32 v29, 0x3b124925, v29
    v_fma_f32 v29, -v28, v28, v29
    v_add_f32 v28, s52, v28
    v_max_f32 v29, 0, v29
    v_cvt_pk_bf16_f32 v30, v28, v29
    v_lshlrev_b32 v28, 16, v30
    v_and_b32 v29, 0xffff0000, v30
    v_add_f32 v29, 0x3727c5ac, v29
    v_cvt_pk_bf16_f32 v29, v29, v29
    v_and_b32 v29, 0xffff0000, v29
    v_sqrt_f32 v29, v29
    v_sub_f32 v32, v20, v28
    v_sub_f32 v33, v21, v28
    v_sub_f32 v34, v22, v28
    v_sub_f32 v35, v23, v28
    v_sub_f32 v36, v24, v28
    v_sub_f32 v37, v25, v28
    v_sub_f32 v38, v26, v28
    v_sub_f32 v39, v27, v28
    v_cvt_pk_bf16_f32 v29, v29, v29
    v_and_b32 v29, 0xffff0000, v29
    v_rcp_f32 v31, v29
    v_cvt_pk_bf16_f32 v40, v32, v33
    v_cvt_pk_bf16_f32 v41, v34, v35
    v_cvt_pk_bf16_f32 v42, v36, v37
    v_cvt_pk_bf16_f32 v43, v38, v39
    v_lshlrev_b32 v32, 16, v40
    v_and_b32 v33, 0xffff0000, v40
    v_lshlrev_b32 v34, 16, v41
    v_and_b32 v35, 0xffff0000, v41
    v_lshlrev_b32 v36, 16, v42
    v_and_b32 v37, 0xffff0000, v42
    v_lshlrev_b32 v38, 16, v43
    v_and_b32 v39, 0xffff0000, v43
    v_mul_f32 v20, v32, v31
    v_mul_f32 v21, v33, v31
    v_mul_f32 v22, v34, v31
    v_mul_f32 v23, v35, v31
    v_mul_f32 v24, v36, v31
    v_mul_f32 v25, v37, v31
    v_mul_f32 v26, v38, v31
    v_mul_f32 v27, v39, v31
    v_fma_f32 v32, -v20, v29, v32
    v_fma_f32 v33, -v21, v29, v33
    v_fma_f32 v34, -v22, v29, v34
    v_fma_f32 v35, -v23, v29, v35
    v_fma_f32 v36, -v24, v29, v36
    v_fma_f32 v37, -v25, v29, v37
    v_fma_f32 v38, -v26, v29, v38
    v_fma_f32 v39, -v27, v29, v39
    v_fmac_f32 v20, v32, v31
    v_fmac_f32 v21, v33, v31
    v_fmac_f32 v22, v34, v31
    v_fmac_f32 v23, v35, v31
    v_fmac_f32 v24, v36, v31
    v_fmac_f32 v25, v37, v31
    v_fmac_f32 v26, v38, v31
    v_fmac_f32 v27, v39, v31
    v_cvt_pk_bf16_f32 v40, v20, v21
    v_cvt_pk_bf16_f32 v41, v22, v23
    v_cvt_pk_bf16_f32 v42, v24, v25
    v_cvt_pk_bf16_f32 v43, v26, v27
    v_add_u32 v6, s48, v3
    v_add_u32 v6, 146432, v6
    v_mov_b32 v7, 1
    s_mov_b32 exec_hi, 0x00ffffff
    ds_write_b128 v6, v[40:43]
    s_waitcnt lgkmcnt(0)
    s_mov_b64 exec, 1
    ds_add_u32 v9, v7 offset:0
    s_mov_b64 exec, -1
    s_cmp_eq_u32 s3, 0
    s_cbranch_scc1 L_h0_land
    s_cmp_eq_u32 s3, 2
    s_cbranch_scc0 L_h_q
    s_waitcnt vmcnt(0)
    v_add_u32 v17, 1, v16
    s_mov_b32 s52, 0x9e3779b1
    v_mul_lo_u32 v16, v17, s52
    s_mov_b64 exec, 1
    ds_write_b32 v9, v16 offset:8
    s_waitcnt lgkmcnt(0)
    ds_add_u32 v9, v7 offset:0
    s_mov_b64 exec, -1
    s_branch L_h_q
L_h0_land:
    s_waitcnt vmcnt(0)
    s_mov_b64 exec, 1
    ds_add_u32 v9, v7 offset:0
    s_mov_b64 exec, -1
L_h_q:
    s_mov_b32 s96, 800000
L_lw_73:
    ds_read_b32 v8, v9 offset:0
    s_waitcnt lgkmcnt(0)
    v_readfirstlane_b32 s52, v8
    s_sub_u32 s96, s96, 1
    s_cbranch_scc1 L_lwd_74
    s_cmp_ge_u32 s52, 6
    s_cbranch_scc0 L_lw_73
L_lwd_74:
    ds_read_b32 v16, v9 offset:8
    ds_read_b64_tr_b16 v[32:33], v19 offset:0
    ds_read_b64 v[48:49], v18 offset:0
    ds_read_b64_tr_b16 v[34:35], v19 offset:2048
    ds_read_b64 v[50:51], v18 offset:32
    ds_read_b64_tr_b16 v[36:37], v19 offset:4096
    ds_read_b64 v[52:53], v18 offset:64
    ds_read_b64_tr_b16 v[38:39], v19 offset:6144
    ds_read_b64 v[54:55], v18 offset:96
    ds_read_b64_tr_b16 v[40:41], v19 offset:8192
    ds_read_b64 v[56:57], v18 offset:128
    ds_read_b64_tr_b16 v[42:43], v19 offset:10240
    ds_read_b64 v[58:59], v18 offset:160
    ds_read_b64_tr_b16 v[44:45], v19 offset:12288
    ds_read_b64 v[60:61], v18 offset:192
    s_waitcnt lgkmcnt(12)
    v_mfma_f32_16x16x16_bf16 v[64:67], v[32:33], v[48:49], 0
    s_waitcnt lgkmcnt(10)
    v_mfma_f32_16x16x16_bf16 v[64:67], v[34:35], v[50:51], v[64:67]
    s_waitcnt lgkmcnt(8)
    v_mfma_f32_16x16x16_bf16 v[64:67], v[36:37], v[52:53], v[64:67]
    s_waitcnt lgkmcnt(6)
    v_mfma_f32_16x16x16_bf16 v[64:67], v[38:39], v[54:55], v[64:67]
    s_waitcnt lgkmcnt(4)
    v_mfma_f32_16x16x16_bf16 v[64:67], v[40:41], v[56:57], v[64:67]
    s_waitcnt lgkmcnt(2)
    v_mfma_f32_16x16x16_bf16 v[64:67], v[42:43], v[58:59], v[64:67]
    s_waitcnt lgkmcnt(0)
    v_mfma_f32_16x16x16_bf16 v[64:67], v[44:45], v[60:61], v[64:67]
    s_nop 7
    v_add_u32 v64, 0x80, v64
    v_add_u32 v65, 0x80, v65
    v_add_u32 v66, 0x80, v66
    v_add_u32 v67, 0x80, v67
    v_perm_b32 v64, v64, v67, s70
    v_perm_b32 v65, v65, v67, s71
    v_perm_b32 v66, v66, v67, s72
    v_mov_b32 v67, v16
    s_mov_b32 exec_lo, 0x000f000f
    s_mov_b32 exec_hi, 0x000f000f
    ds_write_b128 v13, v[64:67]
    s_mov_b64 exec, -1
    s_waitcnt lgkmcnt(0)
    s_mov_b64 exec, 1
    ds_add_u32 v9, v7 offset:4
    s_mov_b64 exec, -1
    s_cmp_lg_u32 s3, 0
    s_cbranch_scc1 L_h_qp
    s_mov_b32 s96, 800000
L_lw_75:
    ds_read_b32 v8, v9 offset:4
    s_waitcnt lgkmcnt(0)
    v_readfirstlane_b32 s52, v8
    s_sub_u32 s96, s96, 1
    s_cbranch_scc1 L_lwd_76
    s_cmp_ge_u32 s52, 4
    s_cbranch_scc0 L_lw_75
L_lwd_76:
    v_add_u32 v8, 159936, v3
    ds_read_b128 v[64:67], v8
    s_waitcnt lgkmcnt(0)
    buffer_store_dwordx4 v[64:67], v14, s[36:39], s58 offen sc1
L_h_qp:
    s_mov_b32 s40, s20
    s_mov_b32 s41, s21
    s_mov_b32 s42, 1605632
    s_mov_b32 s43, 0x00020000
    s_and_b32 s49, s61, 63
    s_mul_i32 s49, s49, 28
    s_mul_i32 s50, s3, 7
    s_add_u32 s49, s49, s50
    s_mul_i32 s49, s49, 896
    s_mov_b32 exec_hi, 0x00ffffff
    buffer_load_dwordx4 v[96:99], v3, s[40:43], s49 offen
    s_add_u32 s49, s49, 896
    buffer_load_dwordx4 v[100:103], v3, s[40:43], s49 offen
    s_add_u32 s49, s49, 896
    buffer_load_dwordx4 v[104:107], v3, s[40:43], s49 offen
    s_add_u32 s49, s49, 896
    buffer_load_dwordx4 v[108:111], v3, s[40:43], s49 offen
    s_add_u32 s49, s49, 896
    buffer_load_dwordx4 v[112:115], v3, s[40:43], s49 offen
    s_add_u32 s49, s49, 896
    buffer_load_dwordx4 v[116:119], v3, s[40:43], s49 offen
    s_add_u32 s49, s49, 896
    buffer_load_dwordx4 v[120:123], v3, s[40:43], s49 offen
    s_mov_b64 exec, -1
    s_cmp_eq_u32 s62, -1
    s_cbranch_scc1 L_bkd
    s_and_b32 s52, s62, 3
    s_lshr_b32 s53, s62, 2
    s_cmp_ge_u32 s53, 28
    s_cselect_b32 s40, s18, s16
    s_cselect_b32 s41, s19, s17
    s_cselect_b32 s54, 28, 0
    s_sub_u32 s53, s53, s54
    s_mov_b32 s42, 1605632
    v_mul_u32_u24 v6, 3584, v236
    v_add_u32 v6, v6, v237
    s_mul_i32 s49, s52, 401408
    s_lshl_b32 s53, s53, 7
    s_add_u32 s49, s49, s53
    s_mul_i32 s50, s3, 114688
    s_add_u32 s49, s49, s50
    buffer_load_dwordx4 v[128:131], v6, s[40:43], s49 offen nt
    s_add_u32 s49, s49, 28672
    buffer_load_dwordx4 v[132:135], v6, s[40:43], s49 offen nt
    s_add_u32 s49, s49, 28672
    s_cmp_eq_u32 s3, 3
    s_cbranch_scc1 L_bkd
    buffer_load_dwordx4 v[136:139], v6, s[40:43], s49 offen nt
    s_add_u32 s49, s49, 28672
    buffer_load_dwordx4 v[140:143], v6, s[40:43], s49 offen nt
L_bkd:
    s_lshl_b32 s52, s47, 2
    s_add_u32 s52, s52, s46
    s_lshl_b32 s52, s52, 13
    s_lshl_b32 s53, s3, 11
    s_add_u32 s52, s52, s53
    s_add_u32 s52, s52, 65536
    s_mov_b32 s96, 40000
    buffer_load_dwordx4 v[64:67], v3, s[36:39], s52 offen offset:0 sc1
    buffer_load_dwordx4 v[68:71], v3, s[36:39], s52 offen offset:1024 sc1
    s_sleep 24
L_hq_poll:
    buffer_load_dwordx4 v[72:75], v3, s[36:39], s52 offen offset:0 sc1
    buffer_load_dwordx4 v[76:79], v3, s[36:39], s52 offen offset:1024 sc1
    s_waitcnt vmcnt(2)
    v_cmp_eq_u32 s[54:55], v67, v16
    v_cmp_eq_u32 vcc, v71, v16
    s_and_b64 s[54:55], s[54:55], vcc
    s_cmp_eq_u64 s[54:55], exec
    s_cbranch_scc1 L_hq_gotA
    s_sub_u32 s96, s96, 1
    s_cbranch_scc1 L_hq_gotA
    s_sleep 2
    buffer_load_dwordx4 v[64:67], v3, s[36:39], s52 offen offset:0 sc1
    buffer_load_dwordx4 v[68:71], v3, s[36:39], s52 offen offset:1024 sc1
    s_waitcnt vmcnt(2)
    v_cmp_eq_u32 s[54:55], v75, v16
    v_cmp_eq_u32 vcc, v79, v16
    s_and_b64 s[54:55], s[54:55], vcc
    s_cmp_eq_u64 s[54:55], exec
    s_cbranch_scc1 L_hq_gotB
    s_sleep 2
    s_branch L_hq_poll
L_hq_gotB:
    v_perm_b32 v75, v72, v73, s73
    v_perm_b32 v75, v75, v74, s74
    v_and_b32 v72, 0xffffff00, v72
    v_and_b32 v73, 0xffffff00, v73
    v_and_b32 v74, 0xffffff00, v74
    v_perm_b32 v79, v76, v77, s73
    v_perm_b32 v79, v79, v78, s74
    v_and_b32 v76, 0xffffff00, v76
    v_and_b32 v77, 0xffffff00, v77
    v_and_b32 v78, 0xffffff00, v78
    v_mov_b32 v32, v72
    v_mov_b32 v33, v73
    v_mov_b32 v34, v74
    v_mov_b32 v35, v75
    v_mov_b32 v36, v76
    v_mov_b32 v37, v77
    v_mov_b32 v38, v78
    v_mov_b32 v39, v79
    v_permlane16_swap_b32 v72, v32
    v_permlane16_swap_b32 v73, v33
    v_permlane16_swap_b32 v74, v34
    v_permlane16_swap_b32 v75, v35
    v_permlane16_swap_b32 v76, v36
    v_permlane16_swap_b32 v77, v37
    v_permlane16_swap_b32 v78, v38
    v_permlane16_swap_b32 v79, v39
    v_add_f32 v72, v72, v32
    v_add_f32 v73, v73, v33
    v_add_f32 v74, v74, v34
    v_add_f32 v75, v75, v35
    v_add_f32 v76, v76, v36
    v_add_f32 v77, v77, v37
    v_add_f32 v78, v78, v38
    v_add_f32 v79, v79, v39
    v_mov_b32 v32, v72
    v_mov_b32 v33, v73
    v_mov_b32 v34, v74
    v_mov_b32 v35, v75
    v_mov_b32 v36, v76
    v_mov_b32 v37, v77
    v_mov_b32 v38, v78
    v_mov_b32 v39, v79
    v_permlane32_swap_b32 v72, v32
    v_permlane32_swap_b32 v73, v33
    v_permlane32_swap_b32 v74, v34
    v_permlane32_swap_b32 v75, v35
    v_permlane32_swap_b32 v76, v36
    v_permlane32_swap_b32 v77, v37
    v_permlane32_swap_b32 v78, v38
    v_permlane32_swap_b32 v79, v39
    v_add_f32 v72, v72, v32
    v_add_f32 v73, v73, v33
    v_add_f32 v74, v74, v34
    v_add_f32 v75, v75, v35
    v_add_f32 v76, v76, v36
    v_add_f32 v77, v77, v37
    v_add_f32 v78, v78, v38
    v_add_f32 v79, v79, v39
    v_cvt_pk_bf16_f32 v72, v72, v73
    v_cvt_pk_bf16_f32 v73, v74, v75
    v_cvt_pk_bf16_f32 v76, v76, v77
    v_cvt_pk_bf16_f32 v77, v78, v79
    v_and_b32 v8, 15, v1
    v_lshlrev_b32 v8, 3, v8
    s_lshl_b32 s52, s3, 8
    s_add_u32 s52, s52, 150016
    v_add_u32 v8, s52, v8
    s_mov_b64 exec, 0xffff
    ds_write_b64 v8, v[72:73] offset:0
    ds_write_b64 v8, v[76:77] offset:128
    s_branch L_hq_fin
L_hq_gotA:
    v_perm_b32 v67, v64, v65, s73
    v_perm_b32 v67, v67, v66, s74
    v_and_b32 v64, 0xffffff00, v64
    v_and_b32 v65, 0xffffff00, v65
    v_and_b32 v66, 0xffffff00, v66
    v_perm_b32 v71, v68, v69, s73
    v_perm_b32 v71, v71, v70, s74
    v_and_b32 v68, 0xffffff00, v68
    v_and_b32 v69, 0xffffff00, v69
    v_and_b32 v70, 0xffffff00, v70
    v_mov_b32 v32, v64
    v_mov_b32 v33, v65
    v_mov_b32 v34, v66
    v_mov_b32 v35, v67
    v_mov_b32 v36, v68
    v_mov_b32 v37, v69
    v_mov_b32 v38, v70
    v_mov_b32 v39, v71
    v_permlane16_swap_b32 v64, v32
    v_permlane16_swap_b32 v65, v33
    v_permlane16_swap_b32 v66, v34
    v_permlane16_swap_b32 v67, v35
    v_permlane16_swap_b32 v68, v36
    v_permlane16_swap_b32 v69, v37
    v_permlane16_swap_b32 v70, v38
    v_permlane16_swap_b32 v71, v39
    v_add_f32 v64, v64, v32
    v_add_f32 v65, v65, v33
    v_add_f32 v66, v66, v34
    v_add_f32 v67, v67, v35
    v_add_f32 v68, v68, v36
    v_add_f32 v69, v69, v37
    v_add_f32 v70, v70, v38
    v_add_f32 v71, v71, v39
    v_mov_b32 v32, v64
    v_mov_b32 v33, v65
    v_mov_b32 v34, v66
    v_mov_b32 v35, v67
    v_mov_b32 v36, v68
    v_mov_b32 v37, v69
    v_mov_b32 v38, v70
    v_mov_b32 v39, v71
    v_permlane32_swap_b32 v64, v32
    v_permlane32_swap_b32 v65, v33
    v_permlane32_swap_b32 v66, v34
    v_permlane32_swap_b32 v67, v35
    v_permlane32_swap_b32 v68, v36
    v_permlane32_swap_b32 v69, v37
    v_permlane32_swap_b32 v70, v38
    v_permlane32_swap_b32 v71, v39
    v_add_f32 v64, v64, v32
    v_add_f32 v65, v65, v33
    v_add_f32 v66, v66, v34
    v_add_f32 v67, v67, v35
    v_add_f32 v68, v68, v36
    v_add_f32 v69, v69, v37
    v_add_f32 v70, v70, v38
    v_add_f32 v71, v71, v39
    v_cvt_pk_bf16_f32 v64, v64, v65
    v_cvt_pk_bf16_f32 v65, v66, v67
    v_cvt_pk_bf16_f32 v68, v68, v69
    v_cvt_pk_bf16_f32 v69, v70, v71
    v_and_b32 v8, 15, v1
    v_lshlrev_b32 v8, 3, v8
    s_lshl_b32 s52, s3, 8
    s_add_u32 s52, s52, 150016
    v_add_u32 v8, s52, v8
    s_mov_b64 exec, 0xffff
    ds_write_b64 v8, v[64:65] offset:0
    ds_write_b64 v8, v[68:69] offset:128
L_hq_fin:
    s_waitcnt lgkmcnt(0)
    s_mov_b64 exec, 1
    ds_add_u32 v9, v7 offset:12
    s_mov_b64 exec, -1
    s_cmp_eq_u32 s62, -1
    s_cbranch_scc1 L_aq_done
    s_mov_b32 s96, 800000
L_lw_77:
    ds_read_b32 v8, v9 offset:4
    s_waitcnt lgkmcnt(0)
    v_readfirstlane_b32 s52, v8
    s_sub_u32 s96, s96, 1
    s_cbranch_scc1 L_lwd_78
    s_cmp_ge_u32 s52, 4
    s_cbranch_scc0 L_lw_77
L_lwd_78:
    s_lshl_b32 s52, s3, 12
    s_add_u32 s52, s52, 131072
    v_add_u32 v6, s52, v3
    s_waitcnt vmcnt(0)
    ds_write_b128 v6, v[128:131]
    ds_write_b128 v6, v[132:135] offset:1024
    s_cmp_eq_u32 s3, 3
    s_cbranch_scc1 L_aq_w
    ds_write_b128 v6, v[136:139] offset:2048
    ds_write_b128 v6, v[140:143] offset:3072
L_aq_w:
    s_waitcnt lgkmcnt(0)
    s_mov_b64 exec, 1
    ds_add_u32 v9, v7 offset:24
    s_mov_b64 exec, -1
L_aq_done:
    s_cmp_eq_u32 s3, 0
    s_cbranch_scc1 L_h0
    s_cmp_eq_u32 s3, 1
    s_cbranch_scc1 L_h1
    s_cmp_eq_u32 s3, 3
    s_cbranch_scc1 L_h3
L_h2:
    s_mov_b32 s96, 800000
L_lw_79:
    s_sleep 4
    ds_read_b32 v8, v9 offset:40
    s_waitcnt lgkmcnt(0)
    v_readfirstlane_b32 s48, v8
    s_sub_u32 s96, s96, 1
    s_cbranch_scc1 L_lwd_80
    s_cmp_ge_u32 s48, 4
    s_cbranch_scc0 L_lw_79
L_lwd_80:
    s_memrealtime s[90:91]
    v_mov_b32 v4, 159488
    ds_read_b128 v[40:43], v4
    ds_read_b128 v[44:47], v4 offset:16
    ds_read_b128 v[48:51], v4 offset:32
    ds_read_b128 v[52:55], v4 offset:48
    s_xor_b32 s56, s60, 3
    s_add_u32 s56, s56, s47
    s_and_b32 s56, s56, 7
    s_lshl_b32 s57, s44, 3
    s_add_u32 s59, s57, s56
    s_mul_i32 s50, s44, 4352
    s_add_u32 s50, s50, 1574912
    s_lshl_b32 s57, s56, 4
    s_add_u32 s57, s57, s50
    s_lshl_b32 s52, s45, 4
    s_add_u32 s50, s50, s52
    s_waitcnt lgkmcnt(0)
    v_max3_f32 v33, v40, v42, v44
    v_max3_f32 v33, v33, v46, v48
    v_max3_f32 v33, v33, v50, v52
    v_max_f32 v33, v33, v54
    v_min3_f32 v34, v40, v42, v44
    v_min3_f32 v34, v34, v46, v48
    v_min3_f32 v34, v34, v50, v52
    v_min_f32 v34, v34, v54
    v_mov_b32 v32, s90
    v_mov_b32 v35, v16
    v_mov_b32 v4, 0
    s_mov_b64 exec, 1
    buffer_store_dwordx4 v[32:35], v4, s[36:39], s50 offen sc1
    s_mov_b64 exec, -1
    s_mov_b32 s96, 40000
L_h2_poll:
    buffer_load_dwordx4 v[36:39], v4, s[36:39], s57 offen sc1
    s_waitcnt vmcnt(0)
    v_readfirstlane_b32 s52, v39
    v_readfirstlane_b32 s53, v36
    v_readfirstlane_b32 s54, v16
    s_sub_u32 s96, s96, 1
    s_cbranch_scc1 L_h2_got
    s_cmp_eq_u32 s52, s54
    s_cbranch_scc1 L_h2_got
    s_sleep 8
    s_branch L_h2_poll
L_h2_got:
    s_sub_i32 s55, s90, s53
    s_bitcmp1_b32 s60, 0
    s_cbranch_scc1 L_h2_odd
    s_sub_i32 s55, 0, s55
L_h2_odd:
    s_mul_i32 s55, s55, 18
    s_add_i32 s55, s55, 600
    s_abs_i32 s56, s55
    s_add_u32 s56, s56, 500
    s_mul_hi_u32 s56, s56, 4294968
    s_min_u32 s56, s56, 16
    s_cmp_gt_i32 s55, 0
    s_cselect_b32 s57, 1, 0
    s_and_b32 s58, s60, 1
    s_xor_b32 s57, s57, s58
    s_xor_b32 s57, s57, 1
    v_sub_f32 v40, v33, v38
    v_sub_f32 v41, v37, v34
    s_cmp_eq_u32 s57, 1
    s_cselect_b64 vcc, -1, 0
    v_cndmask_b32 v40, v41, v40, vcc
    v_cmp_ge_f32 vcc, 0x42700000, v40
    s_cmp_eq_u64 vcc, exec
    s_cselect_b32 s56, s56, 0
    s_lshl_b32 s52, s57, 1
    s_lshl_b32 s53, s56, 2
    s_or_b32 s52, s52, s53
    s_or_b32 s52, s52, 1
    v_mov_b32 v32, s52
    s_mov_b64 exec, 1
    ds_write_b32 v9, v32 offset:28
    s_mov_b64 exec, -1
    s_cmp_eq_u32 s56, 0
    s_cbranch_scc1 L_hw
    v_and_b32 v44, 1, v1
    v_lshlrev_b32 v44, 3, v44
    v_bfe_u32 v42, v1, 3, 2
    v_lshrrev_b32 v40, 5, v1
    v_add_u32 v40, 0, v40
    v_sub_u32 v41, s56, v40
    v_add_u32 v41, 3, v41
    v_lshrrev_b32 v41, 2, v41
    v_add_u32 v41, v41, v42
    v_cmp_le_u32 vcc, 4, v41
    s_mov_b64 s[92:93], vcc
    v_lshlrev_b32 v43, 4, v40
    v_add_u32 v43, v43, v44
    v_add_u32 v43, 159488, v43
    ds_read_b32 v56, v43
    v_lshrrev_b32 v40, 5, v1
    v_add_u32 v40, 2, v40
    v_sub_u32 v41, s56, v40
    v_add_u32 v41, 3, v41
    v_lshrrev_b32 v41, 2, v41
    v_add_u32 v41, v41, v42
    v_cmp_le_u32 vcc, 4, v41
    s_mov_b64 s[94:95], vcc
    v_lshlrev_b32 v43, 4, v40
    v_add_u32 v43, v43, v44
    v_add_u32 v43, 159488, v43
    ds_read_b32 v57, v43
    v_lshlrev_b32 v45, 3, v1
    s_cmp_eq_u32 s57, 0
    s_cbranch_scc1 L_h2_recv
    v_add_u32 v47, 160960, v45
    ds_read_b64 v[48:49], v47
    ds_read_b64 v[60:61], v47 offset:512
    s_lshl_b32 s50, s61, 11
    s_add_u32 s50, s50, 1835008
    v_mov_b32 v51, v16
    v_mov_b32 v63, v16
    s_waitcnt lgkmcnt(0)
    v_mov_b32 v50, v56
    v_mov_b32 v62, v57
    s_mov_b64 exec, s[92:93]
    s_cbranch_execz L_h2_g1
    buffer_store_dwordx4 v[48:51], v3, s[36:39], s50 offen sc1
L_h2_g1:
    s_mov_b64 exec, s[94:95]
    s_cbranch_execz L_h2_g2
    buffer_store_dwordx4 v[60:63], v3, s[36:39], s50 offen offset:1024 sc1
L_h2_g2:
    s_mov_b64 exec, -1
    s_branch L_hw
L_h2_recv:
    s_lshl_b32 s50, s59, 11
    s_add_u32 s50, s50, 1835008
    s_mov_b32 s96, 40000
    s_mov_b64 exec, s[92:93]
    s_cbranch_execz L_h2_rn0
L_h2_rp0:
    buffer_load_dwordx4 v[48:51], v3, s[36:39], s50 offen offset:0 sc1
    s_waitcnt vmcnt(0) lgkmcnt(0)
    v_cmp_eq_u32 vcc, v51, v16
    s_sub_u32 s96, s96, 1
    s_cbranch_scc1 L_h2_rg0
    s_cmp_eq_u64 vcc, exec
    s_cbranch_scc1 L_h2_rg0
    s_sleep 8
    s_branch L_h2_rp0
L_h2_rg0:
    v_sub_f32 v50, v50, v56
    v_exp_f32 v50, v50
    v_lshlrev_b32 v52, 16, v48
    v_and_b32 v53, 0xffff0000, v48
    v_lshlrev_b32 v54, 16, v49
    v_and_b32 v55, 0xffff0000, v49
    v_mul_f32 v52, v52, v50
    v_mul_f32 v53, v53, v50
    v_mul_f32 v54, v54, v50
    v_mul_f32 v55, v55, v50
    v_cvt_pk_bf16_f32 v52, v52, v53
    v_cvt_pk_bf16_f32 v53, v54, v55
    v_add_u32 v47, 161984, v45
    ds_write_b64 v47, v[52:53]
L_h2_rn0:
    s_mov_b64 exec, -1
    s_mov_b32 s96, 40000
    s_mov_b64 exec, s[94:95]
    s_cbranch_execz L_h2_rn1
L_h2_rp1:
    buffer_load_dwordx4 v[60:63], v3, s[36:39], s50 offen offset:1024 sc1
    s_waitcnt vmcnt(0) lgkmcnt(0)
    v_cmp_eq_u32 vcc, v63, v16
    s_sub_u32 s96, s96, 1
    s_cbranch_scc1 L_h2_rg1
    s_cmp_eq_u64 vcc, exec
    s_cbranch_scc1 L_h2_rg1
    s_sleep 8
    s_branch L_h2_rp1
L_h2_rg1:
    v_sub_f32 v62, v62, v57
    v_exp_f32 v62, v62
    v_lshlrev_b32 v52, 16, v60
    v_and_b32 v53, 0xffff0000, v60
    v_lshlrev_b32 v54, 16, v61
    v_and_b32 v55, 0xffff0000, v61
    v_mul_f32 v52, v52, v62
    v_mul_f32 v53, v53, v62
    v_mul_f32 v54, v54, v62
    v_mul_f32 v55, v55, v62
    v_cvt_pk_bf16_f32 v52, v52, v53
    v_cvt_pk_bf16_f32 v53, v54, v55
    v_add_u32 v47, 162496, v45
    ds_write_b64 v47, v[52:53]
L_h2_rn1:
    s_mov_b64 exec, -1
    s_waitcnt lgkmcnt(0)
    s_mov_b64 exec, 1
    ds_add_u32 v9, v7 offset:52
    s_mov_b64 exec, -1
    s_branch L_hw
L_h0:
    s_branch L_hw
L_h1:
    s_cmp_eq_u32 s62, -1
    s_cbranch_scc0 L_h1_go
    s_mov_b64 exec, 1
    ds_add_u32 v9, v7 offset:16
    s_mov_b64 exec, -1
    s_branch L_h1_f1done
L_h1_go:
    s_mov_b32 s96, 800000
L_lw_81:
    ds_read_b32 v8, v9 offset:24
    s_waitcnt lgkmcnt(0)
    v_readfirstlane_b32 s52, v8
    s_sub_u32 s96, s96, 1
    s_cbranch_scc1 L_lwd_82
    s_cmp_ge_u32 s52, 4
    s_cbranch_scc0 L_lw_81
L_lwd_82:
    s_and_b32 s52, s62, 3
    s_waitcnt lgkmcnt(0)
    s_mul_i32 s52, s52, 224
    v_add_u32 v18, s52, v11
    ds_read_b64 v[48:49], v18 offset:0
    ds_read_b64 v[50:51], v18 offset:32
    ds_read_b64 v[52:53], v18 offset:64
    ds_read_b64 v[54:55], v18 offset:96
    ds_read_b64 v[56:57], v18 offset:128
    ds_read_b64 v[58:59], v18 offset:160
    ds_read_b64 v[60:61], v18 offset:192
    v_and_b32 v8, 3, v1
    v_lshlrev_b32 v8, 6, v8
    v_add_u32 v8, v8, v12
    v_bfe_u32 v6, v1, 2, 2
    v_lshlrev_b32 v6, 8, v6
    v_add_u32 v8, v8, v6
    s_lshl_b32 s52, s62, 10
    s_add_u32 s52, s52, 327680
    s_waitcnt vmcnt(0) lgkmcnt(0)
    ds_read_b64_tr_b16 v[160:161], v238 offset:0
    ds_read_b64_tr_b16 v[162:163], v238 offset:2048
    ds_read_b64_tr_b16 v[164:165], v238 offset:4096
    ds_read_b64_tr_b16 v[166:167], v238 offset:6144
    ds_read_b64_tr_b16 v[168:169], v238 offset:8192
    ds_read_b64_tr_b16 v[170:171], v238 offset:10240
    ds_read_b64_tr_b16 v[172:173], v238 offset:12288

    ds_read_b64_tr_b16 v[174:175], v238 offset:32
    ds_read_b64_tr_b16 v[176:177], v238 offset:2080
    ds_read_b64_tr_b16 v[178:179], v238 offset:4128
    ds_read_b64_tr_b16 v[180:181], v238 offset:6176
    ds_read_b64_tr_b16 v[182:183], v238 offset:8224
    ds_read_b64_tr_b16 v[184:185], v238 offset:10272
    ds_read_b64_tr_b16 v[186:187], v238 offset:12320
    s_waitcnt lgkmcnt(7)
    ds_read_b64_tr_b16 v[188:189], v238 offset:64
    ds_read_b64_tr_b16 v[190:191], v238 offset:2112
    ds_read_b64_tr_b16 v[192:193], v238 offset:4160
    ds_read_b64_tr_b16 v[194:195], v238 offset:6208
    ds_read_b64_tr_b16 v[196:197], v238 offset:8256
    ds_read_b64_tr_b16 v[198:199], v238 offset:10304
    ds_read_b64_tr_b16 v[200:201], v238 offset:12352
    s_waitcnt lgkmcnt(7)
    ds_read_b64_tr_b16 v[202:203], v238 offset:96
    ds_read_b64_tr_b16 v[204:205], v238 offset:2144
    ds_read_b64_tr_b16 v[206:207], v238 offset:4192
    ds_read_b64_tr_b16 v[208:209], v238 offset:6240
    ds_read_b64_tr_b16 v[210:211], v238 offset:8288
    ds_read_b64_tr_b16 v[212:213], v238 offset:10336
    ds_read_b64_tr_b16 v[214:215], v238 offset:12384
    s_waitcnt lgkmcnt(7)
    s_waitcnt lgkmcnt(0)
    s_mov_b64 exec, 1
    ds_add_u32 v9, v7 offset:16
    s_mov_b64 exec, -1
    v_mfma_f32_16x16x16_bf16 v[128:131], v[160:161], v[48:49], 0
    v_mfma_f32_16x16x16_bf16 v[128:131], v[162:163], v[50:51], v[128:131]
    v_mfma_f32_16x16x16_bf16 v[128:131], v[164:165], v[52:53], v[128:131]
    v_mfma_f32_16x16x16_bf16 v[128:131], v[166:167], v[54:55], v[128:131]
    v_mfma_f32_16x16x16_bf16 v[128:131], v[168:169], v[56:57], v[128:131]
    v_mfma_f32_16x16x16_bf16 v[128:131], v[170:171], v[58:59], v[128:131]
    v_mfma_f32_16x16x16_bf16 v[128:131], v[172:173], v[60:61], v[128:131]
    v_mfma_f32_16x16x16_bf16 v[132:135], v[174:175], v[48:49], 0
    v_mfma_f32_16x16x16_bf16 v[132:135], v[176:177], v[50:51], v[132:135]
    v_mfma_f32_16x16x16_bf16 v[132:135], v[178:179], v[52:53], v[132:135]
    v_mfma_f32_16x16x16_bf16 v[132:135], v[180:181], v[54:55], v[132:135]
    v_mfma_f32_16x16x16_bf16 v[132:135], v[182:183], v[56:57], v[132:135]
    v_mfma_f32_16x16x16_bf16 v[132:135], v[184:185], v[58:59], v[132:135]
    v_mfma_f32_16x16x16_bf16 v[132:135], v[186:187], v[60:61], v[132:135]
    v_mfma_f32_16x16x16_bf16 v[136:139], v[188:189], v[48:49], 0
    v_mfma_f32_16x16x16_bf16 v[136:139], v[190:191], v[50:51], v[136:139]
    v_mfma_f32_16x16x16_bf16 v[136:139], v[192:193], v[52:53], v[136:139]
    v_mfma_f32_16x16x16_bf16 v[136:139], v[194:195], v[54:55], v[136:139]
    v_mfma_f32_16x16x16_bf16 v[136:139], v[196:197], v[56:57], v[136:139]
    v_mfma_f32_16x16x16_bf16 v[136:139], v[198:199], v[58:59], v[136:139]
    v_mfma_f32_16x16x16_bf16 v[136:139], v[200:201], v[60:61], v[136:139]
    v_mfma_f32_16x16x16_bf16 v[140:143], v[202:203], v[48:49], 0
    v_mfma_f32_16x16x16_bf16 v[140:143], v[204:205], v[50:51], v[140:143]
    v_mfma_f32_16x16x16_bf16 v[140:143], v[206:207], v[52:53], v[140:143]
    v_mfma_f32_16x16x16_bf16 v[140:143], v[208:209], v[54:55], v[140:143]
    v_mfma_f32_16x16x16_bf16 v[140:143], v[210:211], v[56:57], v[140:143]
    v_mfma_f32_16x16x16_bf16 v[140:143], v[212:213], v[58:59], v[140:143]
    v_mfma_f32_16x16x16_bf16 v[140:143], v[214:215], v[60:61], v[140:143]
    s_nop 7
    s_mov_b32 s76, 0x00f000f0
    s_mov_b32 s77, 0x00f000f0
    s_mov_b32 s78, 0x0f000f00
    s_mov_b32 s79, 0x0f000f00
    s_mov_b32 s80, 0xf000f000
    s_mov_b32 s81, 0xf000f000
    v_cndmask_b32 v128, v128, v132, s[76:77]
    v_cndmask_b32 v129, v129, v133, s[76:77]
    v_cndmask_b32 v130, v130, v134, s[76:77]
    v_cndmask_b32 v131, v131, v135, s[76:77]
    v_cndmask_b32 v128, v128, v136, s[78:79]
    v_cndmask_b32 v129, v129, v137, s[78:79]
    v_cndmask_b32 v130, v130, v138, s[78:79]
    v_cndmask_b32 v131, v131, v139, s[78:79]
    v_cndmask_b32 v128, v128, v140, s[80:81]
    v_cndmask_b32 v129, v129, v141, s[80:81]
    v_cndmask_b32 v130, v130, v142, s[80:81]
    v_cndmask_b32 v131, v131, v143, s[80:81]
    v_add_u32 v128, 0x80, v128
    v_add_u32 v129, 0x80, v129
    v_add_u32 v130, 0x80, v130
    v_add_u32 v131, 0x80, v131
    v_perm_b32 v128, v128, v131, s70
    v_perm_b32 v129, v129, v131, s71
    v_perm_b32 v130, v130, v131, s72
    v_mov_b32 v131, v16
    buffer_store_dwordx4 v[128:131], v8, s[36:39], s52 offen sc1
L_h1_f1done:
    s_branch L_hw
L_h3:
    s_mov_b32 s96, 800000
L_lw_83:
    s_sleep 32
    ds_read_b32 v8, v9 offset:20
    s_waitcnt lgkmcnt(0)
    v_readfirstlane_b32 s48, v8
    s_sub_u32 s96, s96, 1
    s_cbranch_scc1 L_lwd_84
    s_cmp_ge_u32 s48, 4
    s_cbranch_scc0 L_lw_83
L_lwd_84:
    v_and_b32 v20, 7, v1
    v_min_u32 v21, 6, v20
    s_and_b32 s48, s61, 63
    s_mul_i32 s48, s48, 7
    v_add_u32 v21, s48, v21
    v_lshrrev_b32 v22, 4, v21
    v_lshrrev_b32 v23, 5, v1
    v_mul_u32_u24 v23, 28, v23
    v_add_u32 v22, v22, v23
    v_lshlrev_b32 v22, 12, v22
    v_bfe_u32 v23, v1, 3, 2
    v_lshlrev_b32 v23, 10, v23
    v_add_u32 v22, v22, v23
    v_bfe_u32 v23, v21, 2, 2
    v_lshlrev_b32 v23, 8, v23
    v_add_u32 v22, v22, v23
    v_and_b32 v23, 3, v21
    v_lshlrev_b32 v23, 4, v23
    v_add_u32 v22, v22, v23
    s_lshl_b32 s49, s46, 6
    s_add_u32 s49, s49, 327680
    s_mov_b32 s96, 40000
L_h3_poll:
    buffer_load_dwordx4 v[32:35], v22, s[36:39], s49 offen sc1
    s_waitcnt vmcnt(0)
    v_cmp_eq_u32 vcc, v35, v16
    s_sub_u32 s96, s96, 1
    s_cbranch_scc1 L_h3_got
    s_cmp_eq_u64 vcc, exec
    s_cbranch_scc1 L_h3_got
    s_sleep 32
    s_branch L_h3_poll
L_h3_got:
    v_perm_b32 v35, v32, v33, s73
    v_perm_b32 v35, v35, v34, s74
    v_and_b32 v32, 0xffffff00, v32
    v_and_b32 v33, 0xffffff00, v33
    v_and_b32 v34, 0xffffff00, v34
    s_nop 1
    v_add_f32_dpp v32, v32, v32 row_ror:8 row_mask:0xf bank_mask:0xf
    v_add_f32_dpp v33, v33, v33 row_ror:8 row_mask:0xf bank_mask:0xf
    v_add_f32_dpp v34, v34, v34 row_ror:8 row_mask:0xf bank_mask:0xf
    v_add_f32_dpp v35, v35, v35 row_ror:8 row_mask:0xf bank_mask:0xf
    v_mov_b32 v36, v32
    v_mov_b32 v37, v33
    v_mov_b32 v38, v34
    v_mov_b32 v39, v35
    v_permlane16_swap_b32 v32, v36
    v_permlane16_swap_b32 v33, v37
    v_permlane16_swap_b32 v34, v38
    v_permlane16_swap_b32 v35, v39
    v_add_f32 v32, v32, v36
    v_add_f32 v33, v33, v37
    v_add_f32 v34, v34, v38
    v_add_f32 v35, v35, v39
    v_mov_b32 v48, v32
    v_mov_b32 v49, v33
    v_mov_b32 v50, v34
    v_mov_b32 v51, v35
    v_permlane32_swap_b32 v32, v48
    v_permlane32_swap_b32 v33, v49
    v_permlane32_swap_b32 v34, v50
    v_permlane32_swap_b32 v35, v51
    v_cvt_pk_bf16_f32 v14, v32, v33
    v_cvt_pk_bf16_f32 v15, v34, v35
    v_cvt_pk_bf16_f32 v20, v48, v49
    v_cvt_pk_bf16_f32 v21, v50, v51
    v_lshlrev_b32 v32, 16, v14
    v_and_b32 v33, 0xffff0000, v14
    v_lshlrev_b32 v34, 16, v15
    v_and_b32 v35, 0xffff0000, v15
    v_lshlrev_b32 v48, 16, v20
    v_and_b32 v49, 0xffff0000, v20
    v_lshlrev_b32 v50, 16, v21
    v_and_b32 v51, 0xffff0000, v21
    s_mov_b32 s55, 0x3d372713
    s_mov_b32 s56, 0xc0135761
    v_mul_f32 v36, v32, v32
    v_mul_f32 v36, v36, v32
    v_fma_f32 v36, v36, s55, v32
    v_mul_f32 v36, s56, v36
    v_exp_f32 v36, v36
    s_nop 0
    v_add_f32 v36, 1.0, v36
    v_rcp_f32 v36, v36
    s_nop 0
    v_mul_f32 v36, v36, v32
    v_mul_f32 v37, v33, v33
    v_mul_f32 v37, v37, v33
    v_fma_f32 v37, v37, s55, v33
    v_mul_f32 v37, s56, v37
    v_exp_f32 v37, v37
    s_nop 0
    v_add_f32 v37, 1.0, v37
    v_rcp_f32 v37, v37
    s_nop 0
    v_mul_f32 v37, v37, v33
    v_mul_f32 v38, v34, v34
    v_mul_f32 v38, v38, v34
    v_fma_f32 v38, v38, s55, v34
    v_mul_f32 v38, s56, v38
    v_exp_f32 v38, v38
    s_nop 0
    v_add_f32 v38, 1.0, v38
    v_rcp_f32 v38, v38
    s_nop 0
    v_mul_f32 v38, v38, v34
    v_mul_f32 v39, v35, v35
    v_mul_f32 v39, v39, v35
    v_fma_f32 v39, v39, s55, v35
    v_mul_f32 v39, s56, v39
    v_exp_f32 v39, v39
    s_nop 0
    v_add_f32 v39, 1.0, v39
    v_rcp_f32 v39, v39
    s_nop 0
    v_mul_f32 v39, v39, v35
    v_cvt_pk_bf16_f32 v14, v36, v37
    v_cvt_pk_bf16_f32 v15, v38, v39
    v_lshlrev_b32 v36, 16, v14
    v_and_b32 v37, 0xffff0000, v14
    v_lshlrev_b32 v38, 16, v15
    v_and_b32 v39, 0xffff0000, v15
    v_mul_f32 v36, v36, v48
    v_mul_f32 v37, v37, v49
    v_mul_f32 v38, v38, v50
    v_mul_f32 v39, v39, v51
    v_cvt_pk_bf16_f32 v40, v36, v37
    v_cvt_pk_bf16_f32 v41, v38, v39
    v_and_b32 v20, 7, v1
    v_cmp_eq_u32 vcc, 7, v20
    v_lshlrev_b32 v20, 3, v20
    v_add_u32 v20, 159680, v20
    v_cndmask_b32 v40, v40, v10, vcc
    v_cndmask_b32 v41, v41, v10, vcc
    s_mov_b64 exec, 0xff
    ds_write_b64 v20, v[40:41]
    s_mov_b64 exec, -1
    s_branch L_hw
L_hw:
    s_mov_b32 s96, 800000
L_lw_85:
    s_sleep 32
    ds_read_b32 v8, v9 offset:20
    s_waitcnt lgkmcnt(0)
    v_readfirstlane_b32 s48, v8
    s_sub_u32 s96, s96, 1
    s_cbranch_scc1 L_lwd_86
    s_cmp_ge_u32 s48, 4
    s_cbranch_scc0 L_lw_85
L_lwd_86:
    s_mov_b32 s96, 800000
L_lw_87:
    s_sleep 4
    ds_read_b32 v8, v9 offset:16
    s_waitcnt lgkmcnt(0)
    v_readfirstlane_b32 s48, v8
    s_sub_u32 s96, s96, 1
    s_cbranch_scc1 L_lwd_88
    s_cmp_ge_u32 s48, 1
    s_cbranch_scc0 L_lw_87
L_lwd_88:
    s_mul_i32 s48, s3, 6496
    s_add_u32 s48, s48, 131072
    s_cmp_eq_u32 s3, 3
    s_cselect_b32 s48, 151296, s48
    v_add_u32 v6, s48, v3
    s_waitcnt vmcnt(0)
    s_mov_b32 exec_hi, 0x00ffffff
    ds_write_b128 v6, v[96:99] offset:0
    ds_write_b128 v6, v[100:103] offset:928
    ds_write_b128 v6, v[104:107] offset:1856
    ds_write_b128 v6, v[108:111] offset:2784
    ds_write_b128 v6, v[112:115] offset:3712
    ds_write_b128 v6, v[116:119] offset:4640
    ds_write_b128 v6, v[120:123] offset:5568
    s_mov_b64 exec, -1
    v_mov_b32 v200, v16
    s_cmp_eq_u32 s3, 3
    s_cbranch_scc1 L_pt_done
    s_cmp_eq_u32 s3, 0
    s_cbranch_scc0 L_pt_t1
    s_mov_b32 s96, 800000
L_lw_89:
    s_sleep 16
    ds_read_b32 v8, v9 offset:32
    s_waitcnt lgkmcnt(0)
    v_readfirstlane_b32 s48, v8
    s_sub_u32 s96, s96, 1
    s_cbranch_scc1 L_lwd_90
    s_cmp_ge_u32 s48, 4
    s_cbranch_scc0 L_lw_89
L_lwd_90:
    v_mov_b32 v4, 159488
    ds_read_b128 v[32:35], v4
    ds_read_b128 v[36:39], v4 offset:16
    ds_read_b128 v[40:43], v4 offset:32
    ds_read_b128 v[44:47], v4 offset:48
    s_waitcnt lgkmcnt(0)
    v_max_f32 v24, v32, v36
    v_max_f32 v26, v34, v38
    v_max3_f32 v24, v24, v40, v44
    v_max3_f32 v26, v26, v42, v46
    v_sub_f32 v48, v32, v24
    v_sub_f32 v52, v34, v26
    v_sub_f32 v49, v36, v24
    v_sub_f32 v53, v38, v26
    v_sub_f32 v50, v40, v24
    v_sub_f32 v54, v42, v26
    v_sub_f32 v51, v44, v24
    v_sub_f32 v55, v46, v26
    v_exp_f32 v48, v48
    v_exp_f32 v49, v49
    v_exp_f32 v50, v50
    v_exp_f32 v51, v51
    v_exp_f32 v52, v52
    v_exp_f32 v53, v53
    v_exp_f32 v54, v54
    v_exp_f32 v55, v55
    s_nop 0
    v_mul_f32 v25, v48, v33
    v_fmac_f32 v25, v49, v37
    v_fmac_f32 v25, v50, v41
    v_fmac_f32 v25, v51, v45
    v_mul_f32 v27, v52, v35
    v_fmac_f32 v27, v53, v39
    v_fmac_f32 v27, v54, v43
    v_fmac_f32 v27, v55, v47
    v_mov_b32 v4, 151168
    s_mov_b64 exec, 1
    ds_write_b128 v4, v[48:51]
    ds_write_b128 v4, v[52:55] offset:16
    s_waitcnt lgkmcnt(0)
    ds_add_u32 v9, v7 offset:36
    s_mov_b64 exec, -1
    v_perm_b32 v24, v24, v27, s70
    v_perm_b32 v25, v25, v27, s71
    v_perm_b32 v26, v26, v27, s72
    v_mov_b32 v27, v200
    s_mul_i32 s50, s44, 4352
    s_lshl_b32 s52, s45, 4
    s_add_u32 s50, s50, s52
    s_add_u32 s50, s50, 1572864
    v_mov_b32 v4, 0
    s_mov_b64 exec, 1
    buffer_store_dwordx4 v[24:27], v4, s[36:39], s50 offen sc1
    s_mov_b64 exec, -1
    v_lshrrev_b32 v4, 4, v1
    v_lshlrev_b32 v4, 4, v4
    s_mul_i32 s50, s44, 4352
    s_add_u32 s50, s50, 1572864
    s_mov_b32 s96, 40000
L_pt_ml:
    buffer_load_dwordx4 v[32:35], v4, s[36:39], s50 offen sc1
    buffer_load_dwordx4 v[36:39], v4, s[36:39], s50 offen offset:64 sc1
    s_waitcnt vmcnt(0)
    v_cmp_eq_u32 s[54:55], v35, v200
    v_cmp_eq_u32 vcc, v39, v200
    s_and_b64 s[54:55], s[54:55], vcc
    s_sub_u32 s96, s96, 1
    s_cbranch_scc1 L_pt_mlg
    s_cmp_eq_u64 s[54:55], exec
    s_cbranch_scc1 L_pt_mlg
    s_sleep 48
    s_branch L_pt_ml
L_pt_mlg:
    v_perm_b32 v35, v32, v33, s73
    v_perm_b32 v35, v35, v34, s74
    v_perm_b32 v39, v36, v37, s73
    v_perm_b32 v39, v39, v38, s74
    s_lshr_b32 s48, s45, 2
    s_cmp_eq_u32 s48, 0
    s_cbranch_scc1 L_pt_h0
    v_mov_b32 v32, v34
    v_mov_b32 v33, v35
    v_mov_b32 v36, v38
    v_mov_b32 v37, v39
L_pt_h0:
    v_max_f32 v24, v32, v36
    v_mov_b32 v25, v24
    s_nop 1
    v_permlane16_swap_b32 v24, v25
    s_nop 1
    v_max_f32 v24, v24, v25
    v_mov_b32 v25, v24
    s_nop 1
    v_permlane32_swap_b32 v24, v25
    s_nop 1
    v_max_f32 v24, v24, v25
    v_sub_f32 v32, v32, v24
    v_sub_f32 v36, v36, v24
    v_exp_f32 v32, v32
    v_exp_f32 v36, v36
    s_nop 0
    v_mul_f32 v24, v32, v33
    v_fmac_f32 v24, v36, v37
    v_mov_b32 v25, v24
    s_nop 1
    v_permlane16_swap_b32 v24, v25
    s_nop 1
    v_add_f32 v24, v24, v25
    v_mov_b32 v25, v24
    s_nop 1
    v_permlane32_swap_b32 v24, v25
    s_nop 1
    v_add_f32 v24, v24, v25
    v_rcp_f32 v24, v24
    s_nop 0
    v_mul_f32 v211, v32, v24
    v_mul_f32 v212, v36, v24
    s_and_b32 s49, s45, 3
    s_lshl_b32 s49, s49, 8
    s_lshl_b32 s50, s48, 10
    s_add_u32 s49, s49, s50
    s_lshl_b32 s50, s44, 14
    s_add_u32 s49, s49, s50
    s_add_u32 s82, s49, 589824
    s_add_u32 s83, s82, 8192
    v_lshrrev_b32 v4, 4, v1
    v_lshlrev_b32 v205, 11, v4
    v_and_b32 v5, 15, v1
    v_lshlrev_b32 v5, 4, v5
    v_add_u32 v205, v205, v5
    v_lshrrev_b32 v207, 1, v5
    v_add_u32 v207, 159552, v207
    v_and_b32 v206, 7, v1
    v_lshlrev_b32 v206, 4, v206
    s_mul_i32 s84, s44, 4352
    s_add_u32 s84, s84, 1573888
    s_branch L_pt_done
L_pt_t1:
    s_mov_b32 s96, 800000
L_lw_91:
    s_sleep 16
    ds_read_b32 v8, v9 offset:36
    s_waitcnt lgkmcnt(0)
    v_readfirstlane_b32 s48, v8
    s_sub_u32 s96, s96, 1
    s_cbranch_scc1 L_lwd_92
    s_cmp_ge_u32 s48, 1
    s_cbranch_scc0 L_lw_91
L_lwd_92:
    s_sub_u32 s48, s3, 1
    s_lshl_b32 s49, s48, 4
    s_add_u32 s49, s49, 151168
    v_mov_b32 v4, s49
    ds_read_b128 v[192:195], v4
    v_lshlrev_b32 v207, 4, v1
    s_lshl_b32 s49, s48, 10
    v_add_u32 v205, s49, v207
    v_add_u32 v206, 65536, v205
    s_lshl_b32 s82, s61, 11
    s_add_u32 s82, s82, s49
    s_add_u32 s82, s82, 589824
    s_mul_i32 s84, s44, 4352
    s_lshl_b32 s52, s45, 4
    s_add_u32 s84, s84, s52
    s_add_u32 s84, s84, 1573888
    s_waitcnt lgkmcnt(0)
L_pt_done:
    s_branch L_tail
L_code_end:
.section .rodata,"a"
.p2align 6
.amdhsa_kernel parallel_sum__gqa_block_cached__glu_gated_geglu__decode_kernel
  .amdhsa_next_free_vgpr 256
  .amdhsa_next_free_sgpr 102
  .amdhsa_accum_offset 256
  .amdhsa_group_segment_fixed_size 0
  .amdhsa_kernarg_size 96
  .amdhsa_user_sgpr_count 2
  .amdhsa_user_sgpr_kernarg_segment_ptr 1
  .amdhsa_system_sgpr_workgroup_id_x 1
.end_amdhsa_kernel
```
